```python
import torch

def _softmax(x, axis=-1):
    return torch.softmax(x, dim=axis)
def _gelu(x):
    return torch.nn.functional.gelu(x, approximate="tanh")
def _silu(x):
    return torch.nn.functional.silu(x)
def _sigmoid(x):
    return torch.sigmoid(x)
def _layernorm(x, axis=-1, eps=1e-5):
    m = x.mean(dim=axis, keepdim=True)
    v = x.var(dim=axis, keepdim=True, unbiased=False)
    return (x - m) / torch.sqrt(v + eps)
def _scatter_add(tgt, idx, src, axis=0):
    return tgt.clone().index_add_(axis, idx, src)
def _segment_sum(src, seg, n):
    out = torch.zeros((n,) + src.shape[1:], dtype=src.dtype)
    return out.index_add_(0, seg, src)
def _pad(x, pw):
    flat = tuple(v for pair in reversed(pw) for v in pair)
    return torch.nn.functional.pad(x, flat)

kernel_name = 'recurrent_scan__spectral_fnet__glu_gated_swiglu__prompt'

def setup_inputs():

    _w = (lambda a: (lambda t: t.to(torch.bfloat16) if t.is_floating_point() else t)(torch.as_tensor(a)))
    def _A_setup():
        B, S, D = 1, 2048, 512
        ns = torch.arange(S)[:, None] * torch.arange(S)[None, :]
        nd = torch.arange(D)[:, None] * torch.arange(D)[None, :]
        Ws_re = torch.cos(-2.0 * torch.pi * ns / S).to(float)
        Ws_im = torch.sin(-2.0 * torch.pi * ns / S).to(float)
        Wd_re = torch.cos(-2.0 * torch.pi * nd / D).to(float)
        Wd_im = torch.sin(-2.0 * torch.pi * nd / D).to(float)
        return {
            "x": _w((lambda *s: torch.randn(*s, dtype=torch.bfloat16) * 0.05)(B, S, D)),
            "dft_seq_re": _w(Ws_re),
            "dft_seq_im": _w(Ws_im),
            "dft_hid_re": _w(Wd_re),
            "dft_hid_im": _w(Wd_im),
        }
    _A_in = _A_setup()

    def _B_setup():
        B, S, D, F = 1, 2048, 512, 1376
        return {
            "x": _w((lambda *s: torch.randn(*s, dtype=torch.bfloat16) * 0.05)(B, S, D)),
            "w1": _w((lambda *s: torch.randn(*s, dtype=torch.bfloat16) * 0.05)(D, F) * (2.0 / D) ** 0.5),
            "w3": _w((lambda *s: torch.randn(*s, dtype=torch.bfloat16) * 0.05)(D, F) * (2.0 / D) ** 0.5),
            "w2": _w((lambda *s: torch.randn(*s, dtype=torch.bfloat16) * 0.05)(F, D) * (2.0 / F) ** 0.5),
        }
    _B_in = _B_setup()

    return {
        "A_x": _A_in["x"],
        "A_dft_seq_re": _A_in["dft_seq_re"],
        "A_dft_seq_im": _A_in["dft_seq_im"],
        "A_dft_hid_re": _A_in["dft_hid_re"],
        "A_dft_hid_im": _A_in["dft_hid_im"],
        "B_x": _B_in["x"],
        "B_w1": _B_in["w1"],
        "B_w3": _B_in["w3"],
        "B_w2": _B_in["w2"],
    }

def reference(A_x, A_dft_seq_re, A_dft_seq_im, A_dft_hid_re, A_dft_hid_im, B_x, B_w1, B_w3, B_w2):
    def _A_ref(x, dft_seq_re, dft_seq_im, dft_hid_re, dft_hid_im):
        a = torch.einsum("bsd,ed->bse", x, dft_hid_re)
        b = torch.einsum("bsd,ed->bse", x, dft_hid_im)
        y = torch.einsum("ts,bse->bte", dft_seq_re, a) - torch.einsum("ts,bse->bte", dft_seq_im, b)
        return y

    def _B_ref(x, w1, w3, w2):
        gate = torch.einsum("bsd,df->bsf", x, w1)
        up = torch.einsum("bsd,df->bsf", x, w3)
        h = _silu(gate) * up
        out = torch.einsum("bsf,fd->bsd", h, w2)
        return out

    x = A_x
    xn = _layernorm(x, axis=-1)
    s = _A_ref(xn, A_dft_seq_re, A_dft_seq_im, A_dft_hid_re, A_dft_hid_im)
    g = _silu(_B_ref(xn, B_w1, B_w3, B_w2))
    return x + s * g
```

```asm
; @launch grid=(256,1,1) block=(512,1,1) lds=163840
.amdgcn_target "amdgcn-amd-amdhsa--gfx950"
.text
.globl recurrent_scan__spectral_fnet__glu_gated_swiglu__prompt_kernel
.p2align 8
.type recurrent_scan__spectral_fnet__glu_gated_swiglu__prompt_kernel,@function
recurrent_scan__spectral_fnet__glu_gated_swiglu__prompt_kernel:
s_cmp_ge_u32 s2, 256
s_cbranch_scc1 Lend
s_load_dwordx2 s[4:5], s[0:1], 0
s_getpc_b64 s[44:45]
Lpc:
s_mov_b32 s46, Lend-Lpc
s_mov_b32 s47, 0x20000
s_bfe_u32 s61, s2, 0x30003
s_mul_i32 s53, s61, 6144
v_mul_u32_u24_e64 v1, 12, v0
buffer_load_dwordx3 v[252:254], v1, s[44:47], s53 offen
v_lshrrev_b32 v1, 6, v0
v_and_b32 v0, 63, v0
v_readfirstlane_b32 s52, v1
s_mov_b32 s6, 2097152
s_mov_b32 s7, s47
s_lshr_b32 s56, s2, 6
s_and_b32 s49, s2, 1
s_lshl_b32 s49, s49, 3
s_add_u32 s49, s49, s61
s_add_u32 s51, s56, s61
s_and_b32 s50, s2, 6
s_lshl_b32 s50, s50, 1
s_add_u32 s50, s50, s56
v_lshrrev_b32 v6, 3, v0
v_and_b32 v7, 7, v0
v_lshlrev_b32_e64 v5, 4, v7
v_lshl_add_u32 v4, v6, 16, v5
s_and_b32 s53, s52, 1
s_bfe_u32 s54, s52, 0x10001
s_lshl_b32 s55, s49, 1
s_add_u32 s55, s55, s53
s_lshl_b32 s57, s54, 5
s_add_u32 s57, s57, s55
s_lshl_b32 s57, s57, 10
s_and_b32 s8, s52, 4
s_xor_b32 s8, s8, 4
s_add_u32 s53, s8, s50
s_add_u32 s8, s8, s51
s_cmp_ge_u32 s53, 18
s_waitcnt lgkmcnt(0)
s_cbranch_scc1 Lnox
s_add_u32 s53, s8, 0
s_and_b32 s53, s53, 7
s_lshl_b32 s53, s53, 7
s_add_u32 s53, s53, s57
buffer_load_dwordx4 v[64:67], v4, s[4:7], s53 offen
s_add_u32 s53, s53, 524288
buffer_load_dwordx4 v[68:71], v4, s[4:7], s53 offen
s_add_u32 s53, s53, 524288
buffer_load_dwordx4 v[72:75], v4, s[4:7], s53 offen
s_add_u32 s53, s53, 524288
buffer_load_dwordx4 v[76:79], v4, s[4:7], s53 offen
s_add_u32 s53, s8, 1
s_and_b32 s53, s53, 7
s_lshl_b32 s53, s53, 7
s_add_u32 s53, s53, s57
buffer_load_dwordx4 v[80:83], v4, s[4:7], s53 offen
s_add_u32 s53, s53, 524288
buffer_load_dwordx4 v[84:87], v4, s[4:7], s53 offen
s_add_u32 s53, s53, 524288
buffer_load_dwordx4 v[88:91], v4, s[4:7], s53 offen
s_add_u32 s53, s53, 524288
buffer_load_dwordx4 v[92:95], v4, s[4:7], s53 offen
Lnox:
s_load_dwordx2 s[16:17], s[0:1], 48
s_load_dwordx2 s[20:21], s[0:1], 56
s_load_dwordx2 s[24:25], s[0:1], 64
s_load_dwordx2 s[28:29], s[0:1], 72
s_load_dwordx2 s[32:33], s[0:1], 80
s_load_dwordx2 s[36:37], s[0:1], 88
s_mov_b32 s18, 1409024
s_mov_b32 s19, 0x20000
s_mov_b32 s22, 1409024
s_mov_b32 s23, 0x20000
s_mov_b32 s26, 1409024
s_mov_b32 s27, 0x20000
s_mov_b32 s30, 2097152
s_mov_b32 s31, 0x20000
s_mov_b32 s34, 256
s_mov_b32 s35, 0x20000
s_mov_b32 s38, 8409088
s_mov_b32 s39, 0x20000
s_and_b32 s48, s52, 3
s_sub_u32 s59, s50, 14
s_mul_i32 s68, s55, 184320
s_lshl_b32 s56, s54, 10
s_add_u32 s68, s68, s56
s_lshl_b32 s73, s55, 5
s_lshl_b32 s56, s50, 1
s_add_u32 s73, s73, s56
s_add_u32 s73, s73, s54
s_lshl_b32 s73, s73, 2
s_add_u32 s73, s73, 8396800
s_lshl_b32 s73, s49, 6
s_add_u32 s73, s73, s50
s_lshl_b32 s73, s73, 2
s_add_u32 s73, s73, 8396800
s_lshl_b32 s63, s48, 12
s_mul_i32 s74, s48, 6144
s_lshl_b32 s75, s48, 13
s_mul_i32 s3, s48, 12288
s_lshl_b32 s46, s48, 14
s_mov_b32 s76, 0xbfb8aa3b
s_mov_b32 s77, 0xbfb8aa3b
s_mov_b32 s66, 0x3f803f80
v_lshrrev_b32 v5, 4, v0
v_xor_b32 v2, v7, v5
v_xor_b32 v3, 4, v2
v_lshlrev_b32 v2, 4, v2
v_lshlrev_b32 v3, 4, v3
v_lshrrev_b32 v16, 2, v0
v_and_b32 v17, 3, v0
v_lshlrev_b32 v17, 4, v17
v_mul_u32_u24 v18, 2752, v16
v_add_u32_e64 v18, v18, v17
v_lshl_add_u32 v20, v16, 10, v17
s_mul_i32 s58, s48, 44032
s_mul_i32 s53, s50, 192
s_add_u32 s58, s58, s53
s_waitcnt lgkmcnt(0)
s_cmp_ge_u32 s50, 14
s_cbranch_scc1 LS
v_and_b32 v12, 31, v0
v_lshrrev_b32 v7, 5, v0
v_bfe_u32 v13, v0, 1, 3
v_xor_b32 v13, v13, v7
v_lshlrev_b32 v12, 7, v12
v_xor_b32_e64 v14, 0, v13
v_lshl_add_u32 v8, v14, 4, v12
v_xor_b32_e64 v14, 2, v13
v_lshl_add_u32 v9, v14, 4, v12
v_xor_b32_e64 v14, 4, v13
v_lshl_add_u32 v10, v14, 4, v12
v_xor_b32_e64 v14, 6, v13
v_lshl_add_u32 v11, v14, 4, v12
v_lshrrev_b32_e64 v5, 5, v0
v_bfe_u32 v7, v0, 2, 2
v_lshl_add_u32 v5, v5, 3, v7
v_lshlrev_b32_e64 v5, 6, v5
v_bfe_u32 v7, v0, 4, 1
v_lshl_add_u32 v5, v7, 5, v5
v_and_b32_e64 v7, 3, v0
v_lshl_add_u32 v5, v7, 3, v5
v_add_u32 v19, 65536, v5
v_add_u32 v21, 114688, v5
s_add_u32 s53, s75, 114688
s_cmp_ge_u32 s52, 4
s_cselect_b32 s53, s63, s53
v_lshl_add_u32 v12, v6, 7, v2
v_lshl_add_u32 v13, v6, 7, v3
v_add_u32 v12, s53, v12
v_add_u32 v13, s53, v13
v_add_u32 v14, s53, v8
v_add_u32 v8, s63, v8
v_add_u32 v15, s53, v9
v_add_u32 v9, s63, v9
v_add_u32 v16, s53, v10
v_add_u32 v10, s63, v10
v_add_u32 v17, s53, v11
v_add_u32 v11, s63, v11
v_mov_b32 v32, 0
v_mov_b32 v33, 0
v_mov_b32 v34, 0
v_mov_b32 v35, 0
v_mov_b32 v36, 0
v_mov_b32 v37, 0
v_mov_b32 v38, 0
v_mov_b32 v39, 0
v_mov_b32 v40, 0
v_mov_b32 v41, 0
v_mov_b32 v42, 0
v_mov_b32 v43, 0
v_mov_b32 v44, 0
v_mov_b32 v45, 0
v_mov_b32 v46, 0
v_mov_b32 v47, 0
s_waitcnt vmcnt(4)
s_add_u32 s53, s8, 2
s_and_b32 s53, s53, 7
s_lshl_b32 s53, s53, 7
s_add_u32 s53, s53, s57
buffer_load_dwordx4 v[96:99], v4, s[4:7], s53 offen
s_add_u32 s53, s53, 524288
buffer_load_dwordx4 v[100:103], v4, s[4:7], s53 offen
s_add_u32 s53, s53, 524288
buffer_load_dwordx4 v[104:107], v4, s[4:7], s53 offen
s_add_u32 s53, s53, 524288
buffer_load_dwordx4 v[108:111], v4, s[4:7], s53 offen
v_lshlrev_b32 v128, 16, v64
v_and_b32 v129, 0xffff0000, v64
v_lshlrev_b32_e64 v136, 16, v68
v_and_b32 v137, 0xffff0000, v68
v_lshlrev_b32_e64 v144, 16, v72
v_and_b32 v145, 0xffff0000, v72
v_lshlrev_b32_e64 v152, 16, v76
v_and_b32 v153, 0xffff0000, v76
v_pk_fma_f32 v[32:33], v[128:129], v[128:129], v[32:33]
v_pk_add_f32 v[40:41], v[128:129], v[40:41]
v_pk_fma_f32 v[34:35], v[136:137], v[136:137], v[34:35]
v_pk_add_f32 v[42:43], v[136:137], v[42:43]
v_pk_fma_f32 v[36:37], v[144:145], v[144:145], v[36:37]
v_pk_add_f32 v[44:45], v[144:145], v[44:45]
v_pk_fma_f32 v[38:39], v[152:153], v[152:153], v[38:39]
v_pk_add_f32 v[46:47], v[152:153], v[46:47]
v_lshlrev_b32_e64 v130, 16, v65
v_and_b32 v131, 0xffff0000, v65
v_lshlrev_b32_e64 v138, 16, v69
v_and_b32 v139, 0xffff0000, v69
v_lshlrev_b32_e64 v146, 16, v73
v_and_b32 v147, 0xffff0000, v73
v_lshlrev_b32_e64 v154, 16, v77
v_and_b32 v155, 0xffff0000, v77
v_pk_fma_f32 v[32:33], v[130:131], v[130:131], v[32:33]
v_pk_add_f32 v[40:41], v[130:131], v[40:41]
v_pk_fma_f32 v[34:35], v[138:139], v[138:139], v[34:35]
v_pk_add_f32 v[42:43], v[138:139], v[42:43]
v_pk_fma_f32 v[36:37], v[146:147], v[146:147], v[36:37]
v_pk_add_f32 v[44:45], v[146:147], v[44:45]
v_pk_fma_f32 v[38:39], v[154:155], v[154:155], v[38:39]
v_pk_add_f32 v[46:47], v[154:155], v[46:47]
v_lshlrev_b32_e64 v132, 16, v66
v_and_b32 v133, 0xffff0000, v66
v_lshlrev_b32_e64 v140, 16, v70
v_and_b32 v141, 0xffff0000, v70
v_lshlrev_b32_e64 v148, 16, v74
v_and_b32 v149, 0xffff0000, v74
v_lshlrev_b32_e64 v156, 16, v78
v_and_b32 v157, 0xffff0000, v78
v_pk_fma_f32 v[32:33], v[132:133], v[132:133], v[32:33]
v_pk_add_f32 v[40:41], v[132:133], v[40:41]
v_pk_fma_f32 v[34:35], v[140:141], v[140:141], v[34:35]
v_pk_add_f32 v[42:43], v[140:141], v[42:43]
v_pk_fma_f32 v[36:37], v[148:149], v[148:149], v[36:37]
v_pk_add_f32 v[44:45], v[148:149], v[44:45]
v_pk_fma_f32 v[38:39], v[156:157], v[156:157], v[38:39]
v_pk_add_f32 v[46:47], v[156:157], v[46:47]
v_lshlrev_b32_e64 v134, 16, v67
v_and_b32 v135, 0xffff0000, v67
v_lshlrev_b32_e64 v142, 16, v71
v_and_b32 v143, 0xffff0000, v71
v_lshlrev_b32_e64 v150, 16, v75
v_and_b32 v151, 0xffff0000, v75
v_lshlrev_b32_e64 v158, 16, v79
v_and_b32 v159, 0xffff0000, v79
v_pk_fma_f32 v[32:33], v[134:135], v[134:135], v[32:33]
v_pk_add_f32 v[40:41], v[134:135], v[40:41]
v_pk_fma_f32 v[34:35], v[142:143], v[142:143], v[34:35]
v_pk_add_f32 v[42:43], v[142:143], v[42:43]
v_pk_fma_f32 v[36:37], v[150:151], v[150:151], v[36:37]
v_pk_add_f32 v[44:45], v[150:151], v[44:45]
v_pk_fma_f32 v[38:39], v[158:159], v[158:159], v[38:39]
v_pk_add_f32 v[46:47], v[158:159], v[46:47]
s_waitcnt vmcnt(4)
s_add_u32 s53, s8, 3
s_and_b32 s53, s53, 7
s_lshl_b32 s53, s53, 7
s_add_u32 s53, s53, s57
buffer_load_dwordx4 v[112:115], v4, s[4:7], s53 offen
s_add_u32 s53, s53, 524288
buffer_load_dwordx4 v[116:119], v4, s[4:7], s53 offen
s_add_u32 s53, s53, 524288
buffer_load_dwordx4 v[120:123], v4, s[4:7], s53 offen
s_add_u32 s53, s53, 524288
buffer_load_dwordx4 v[124:127], v4, s[4:7], s53 offen
v_lshlrev_b32 v160, 16, v80
v_and_b32 v161, 0xffff0000, v80
v_lshlrev_b32_e64 v168, 16, v84
v_and_b32 v169, 0xffff0000, v84
v_lshlrev_b32_e64 v176, 16, v88
v_and_b32 v177, 0xffff0000, v88
v_lshlrev_b32_e64 v184, 16, v92
v_and_b32 v185, 0xffff0000, v92
v_pk_fma_f32 v[32:33], v[160:161], v[160:161], v[32:33]
v_pk_add_f32 v[40:41], v[160:161], v[40:41]
v_pk_fma_f32 v[34:35], v[168:169], v[168:169], v[34:35]
v_pk_add_f32 v[42:43], v[168:169], v[42:43]
v_pk_fma_f32 v[36:37], v[176:177], v[176:177], v[36:37]
v_pk_add_f32 v[44:45], v[176:177], v[44:45]
v_pk_fma_f32 v[38:39], v[184:185], v[184:185], v[38:39]
v_pk_add_f32 v[46:47], v[184:185], v[46:47]
v_lshlrev_b32_e64 v162, 16, v81
v_and_b32 v163, 0xffff0000, v81
v_lshlrev_b32_e64 v170, 16, v85
v_and_b32 v171, 0xffff0000, v85
v_lshlrev_b32_e64 v178, 16, v89
v_and_b32 v179, 0xffff0000, v89
v_lshlrev_b32_e64 v186, 16, v93
v_and_b32 v187, 0xffff0000, v93
v_pk_fma_f32 v[32:33], v[162:163], v[162:163], v[32:33]
v_pk_add_f32 v[40:41], v[162:163], v[40:41]
v_pk_fma_f32 v[34:35], v[170:171], v[170:171], v[34:35]
v_pk_add_f32 v[42:43], v[170:171], v[42:43]
v_pk_fma_f32 v[36:37], v[178:179], v[178:179], v[36:37]
v_pk_add_f32 v[44:45], v[178:179], v[44:45]
v_pk_fma_f32 v[38:39], v[186:187], v[186:187], v[38:39]
v_pk_add_f32 v[46:47], v[186:187], v[46:47]
v_lshlrev_b32_e64 v164, 16, v82
v_and_b32 v165, 0xffff0000, v82
v_lshlrev_b32_e64 v172, 16, v86
v_and_b32 v173, 0xffff0000, v86
v_lshlrev_b32_e64 v180, 16, v90
v_and_b32 v181, 0xffff0000, v90
v_lshlrev_b32_e64 v188, 16, v94
v_and_b32 v189, 0xffff0000, v94
v_pk_fma_f32 v[32:33], v[164:165], v[164:165], v[32:33]
v_pk_add_f32 v[40:41], v[164:165], v[40:41]
v_pk_fma_f32 v[34:35], v[172:173], v[172:173], v[34:35]
v_pk_add_f32 v[42:43], v[172:173], v[42:43]
v_pk_fma_f32 v[36:37], v[180:181], v[180:181], v[36:37]
v_pk_add_f32 v[44:45], v[180:181], v[44:45]
v_pk_fma_f32 v[38:39], v[188:189], v[188:189], v[38:39]
v_pk_add_f32 v[46:47], v[188:189], v[46:47]
v_lshlrev_b32_e64 v166, 16, v83
v_and_b32 v167, 0xffff0000, v83
v_lshlrev_b32_e64 v174, 16, v87
v_and_b32 v175, 0xffff0000, v87
v_lshlrev_b32_e64 v182, 16, v91
v_and_b32 v183, 0xffff0000, v91
v_lshlrev_b32_e64 v190, 16, v95
v_and_b32 v191, 0xffff0000, v95
v_pk_fma_f32 v[32:33], v[166:167], v[166:167], v[32:33]
v_pk_add_f32 v[40:41], v[166:167], v[40:41]
v_pk_fma_f32 v[34:35], v[174:175], v[174:175], v[34:35]
v_pk_add_f32 v[42:43], v[174:175], v[42:43]
v_pk_fma_f32 v[36:37], v[182:183], v[182:183], v[36:37]
v_pk_add_f32 v[44:45], v[182:183], v[44:45]
v_pk_fma_f32 v[38:39], v[190:191], v[190:191], v[38:39]
v_pk_add_f32 v[46:47], v[190:191], v[46:47]
s_waitcnt vmcnt(4)
v_lshlrev_b32 v192, 16, v96
v_and_b32 v193, 0xffff0000, v96
v_lshlrev_b32_e64 v200, 16, v100
v_and_b32 v201, 0xffff0000, v100
v_lshlrev_b32_e64 v208, 16, v104
v_and_b32 v209, 0xffff0000, v104
v_lshlrev_b32_e64 v216, 16, v108
v_and_b32 v217, 0xffff0000, v108
v_pk_fma_f32 v[32:33], v[192:193], v[192:193], v[32:33]
v_pk_add_f32 v[40:41], v[192:193], v[40:41]
v_pk_fma_f32 v[34:35], v[200:201], v[200:201], v[34:35]
v_pk_add_f32 v[42:43], v[200:201], v[42:43]
v_pk_fma_f32 v[36:37], v[208:209], v[208:209], v[36:37]
v_pk_add_f32 v[44:45], v[208:209], v[44:45]
v_pk_fma_f32 v[38:39], v[216:217], v[216:217], v[38:39]
v_pk_add_f32 v[46:47], v[216:217], v[46:47]
v_lshlrev_b32_e64 v194, 16, v97
v_and_b32 v195, 0xffff0000, v97
v_lshlrev_b32_e64 v202, 16, v101
v_and_b32 v203, 0xffff0000, v101
v_lshlrev_b32_e64 v210, 16, v105
v_and_b32 v211, 0xffff0000, v105
v_lshlrev_b32_e64 v218, 16, v109
v_and_b32 v219, 0xffff0000, v109
v_pk_fma_f32 v[32:33], v[194:195], v[194:195], v[32:33]
v_pk_add_f32 v[40:41], v[194:195], v[40:41]
v_pk_fma_f32 v[34:35], v[202:203], v[202:203], v[34:35]
v_pk_add_f32 v[42:43], v[202:203], v[42:43]
v_pk_fma_f32 v[36:37], v[210:211], v[210:211], v[36:37]
v_pk_add_f32 v[44:45], v[210:211], v[44:45]
v_pk_fma_f32 v[38:39], v[218:219], v[218:219], v[38:39]
v_pk_add_f32 v[46:47], v[218:219], v[46:47]
v_lshlrev_b32_e64 v196, 16, v98
v_and_b32 v197, 0xffff0000, v98
v_lshlrev_b32_e64 v204, 16, v102
v_and_b32 v205, 0xffff0000, v102
v_lshlrev_b32_e64 v212, 16, v106
v_and_b32 v213, 0xffff0000, v106
v_lshlrev_b32_e64 v220, 16, v110
v_and_b32 v221, 0xffff0000, v110
v_pk_fma_f32 v[32:33], v[196:197], v[196:197], v[32:33]
v_pk_add_f32 v[40:41], v[196:197], v[40:41]
v_pk_fma_f32 v[34:35], v[204:205], v[204:205], v[34:35]
v_pk_add_f32 v[42:43], v[204:205], v[42:43]
v_pk_fma_f32 v[36:37], v[212:213], v[212:213], v[36:37]
v_pk_add_f32 v[44:45], v[212:213], v[44:45]
v_pk_fma_f32 v[38:39], v[220:221], v[220:221], v[38:39]
v_pk_add_f32 v[46:47], v[220:221], v[46:47]
v_lshlrev_b32_e64 v198, 16, v99
v_and_b32 v199, 0xffff0000, v99
v_lshlrev_b32_e64 v206, 16, v103
v_and_b32 v207, 0xffff0000, v103
v_lshlrev_b32_e64 v214, 16, v107
v_and_b32 v215, 0xffff0000, v107
v_lshlrev_b32_e64 v222, 16, v111
v_and_b32 v223, 0xffff0000, v111
v_pk_fma_f32 v[32:33], v[198:199], v[198:199], v[32:33]
v_pk_add_f32 v[40:41], v[198:199], v[40:41]
v_pk_fma_f32 v[34:35], v[206:207], v[206:207], v[34:35]
v_pk_add_f32 v[42:43], v[206:207], v[42:43]
v_pk_fma_f32 v[36:37], v[214:215], v[214:215], v[36:37]
v_pk_add_f32 v[44:45], v[214:215], v[44:45]
v_pk_fma_f32 v[38:39], v[222:223], v[222:223], v[38:39]
v_pk_add_f32 v[46:47], v[222:223], v[46:47]
s_waitcnt vmcnt(0)
s_barrier
s_cmp_ge_u32 s52, 4
s_cbranch_scc1 Lnob0
s_add_u32 s67, s51, 0
s_and_b32 s67, s67, 7
s_mul_i32 s67, s67, 176128
s_add_u32 s67, s67, s58
s_add_u32 m0, s74, 65536
s_nop 0
buffer_load_dwordx4 v18, s[16:19], s67 offen offset:0 lds
s_add_u32 m0, s74, 66496
s_nop 0
buffer_load_dwordx4 v18, s[16:19], s67 offen offset:64 lds
s_add_u32 m0, s74, 67456
s_nop 0
buffer_load_dwordx4 v18, s[16:19], s67 offen offset:128 lds
s_add_u32 m0, s74, 68608
s_nop 0
buffer_load_dwordx4 v18, s[20:23], s67 offen offset:0 lds
s_add_u32 m0, s74, 69568
s_nop 0
buffer_load_dwordx4 v18, s[20:23], s67 offen offset:64 lds
s_add_u32 m0, s74, 70528
s_nop 0
buffer_load_dwordx4 v18, s[20:23], s67 offen offset:128 lds
Lnob0:
v_lshlrev_b32 v224, 16, v112
v_and_b32 v225, 0xffff0000, v112
v_lshlrev_b32_e64 v232, 16, v116
v_and_b32 v233, 0xffff0000, v116
v_lshlrev_b32_e64 v240, 16, v120
v_and_b32 v241, 0xffff0000, v120
v_lshlrev_b32_e64 v248, 16, v124
v_and_b32 v249, 0xffff0000, v124
v_pk_fma_f32 v[32:33], v[224:225], v[224:225], v[32:33]
v_pk_add_f32 v[40:41], v[224:225], v[40:41]
v_pk_fma_f32 v[34:35], v[232:233], v[232:233], v[34:35]
v_pk_add_f32 v[42:43], v[232:233], v[42:43]
v_pk_fma_f32 v[36:37], v[240:241], v[240:241], v[36:37]
v_pk_add_f32 v[44:45], v[240:241], v[44:45]
v_pk_fma_f32 v[38:39], v[248:249], v[248:249], v[38:39]
v_pk_add_f32 v[46:47], v[248:249], v[46:47]
v_lshlrev_b32_e64 v226, 16, v113
v_and_b32 v227, 0xffff0000, v113
v_lshlrev_b32_e64 v234, 16, v117
v_and_b32 v235, 0xffff0000, v117
v_lshlrev_b32_e64 v242, 16, v121
v_and_b32 v243, 0xffff0000, v121
v_lshlrev_b32_e64 v250, 16, v125
v_and_b32 v251, 0xffff0000, v125
v_pk_fma_f32 v[32:33], v[226:227], v[226:227], v[32:33]
v_pk_add_f32 v[40:41], v[226:227], v[40:41]
v_pk_fma_f32 v[34:35], v[234:235], v[234:235], v[34:35]
v_pk_add_f32 v[42:43], v[234:235], v[42:43]
v_pk_fma_f32 v[36:37], v[242:243], v[242:243], v[36:37]
v_pk_add_f32 v[44:45], v[242:243], v[44:45]
v_pk_fma_f32 v[38:39], v[250:251], v[250:251], v[38:39]
v_pk_add_f32 v[46:47], v[250:251], v[46:47]
v_lshlrev_b32_e64 v228, 16, v114
v_and_b32 v229, 0xffff0000, v114
v_lshlrev_b32_e64 v236, 16, v118
v_and_b32 v237, 0xffff0000, v118
v_lshlrev_b32_e64 v244, 16, v122
v_and_b32 v245, 0xffff0000, v122
v_lshlrev_b32_e64 v252, 16, v126
v_and_b32 v253, 0xffff0000, v126
v_pk_fma_f32 v[32:33], v[228:229], v[228:229], v[32:33]
v_pk_add_f32 v[40:41], v[228:229], v[40:41]
v_pk_fma_f32 v[34:35], v[236:237], v[236:237], v[34:35]
v_pk_add_f32 v[42:43], v[236:237], v[42:43]
v_pk_fma_f32 v[36:37], v[244:245], v[244:245], v[36:37]
v_pk_add_f32 v[44:45], v[244:245], v[44:45]
v_pk_fma_f32 v[38:39], v[252:253], v[252:253], v[38:39]
v_pk_add_f32 v[46:47], v[252:253], v[46:47]
v_lshlrev_b32_e64 v230, 16, v115
v_and_b32 v231, 0xffff0000, v115
v_lshlrev_b32_e64 v238, 16, v119
v_and_b32 v239, 0xffff0000, v119
v_lshlrev_b32_e64 v246, 16, v123
v_and_b32 v247, 0xffff0000, v123
v_lshlrev_b32_e64 v254, 16, v127
v_and_b32 v255, 0xffff0000, v127
v_pk_fma_f32 v[32:33], v[230:231], v[230:231], v[32:33]
v_pk_add_f32 v[40:41], v[230:231], v[40:41]
v_pk_fma_f32 v[34:35], v[238:239], v[238:239], v[34:35]
v_pk_add_f32 v[42:43], v[238:239], v[42:43]
v_pk_fma_f32 v[36:37], v[246:247], v[246:247], v[36:37]
v_pk_add_f32 v[44:45], v[246:247], v[44:45]
v_pk_fma_f32 v[38:39], v[254:255], v[254:255], v[38:39]
v_pk_add_f32 v[46:47], v[254:255], v[46:47]
v_add_f32 v32, v32, v33
v_add_f32 v33, v34, v35
v_add_f32 v34, v36, v37
v_add_f32 v35, v38, v39
v_add_f32 v36, v40, v41
v_add_f32 v37, v42, v43
v_add_f32 v38, v44, v45
v_add_f32 v39, v46, v47
s_lshl_b32 s53, s52, 11
s_add_u32 s53, s53, 147456
v_lshl_add_u32 v5, v0, 4, s53
v_xor_b32 v7, 8192, v5
ds_write_b128 v5, v[32:35]
ds_write_b128 v5, v[36:39] offset:1024
s_waitcnt lgkmcnt(0)
s_barrier
ds_read_b128 v[40:43], v7
ds_read_b128 v[44:47], v7 offset:1024
s_waitcnt lgkmcnt(0)
v_add_f32 v32, v32, v40
v_add_f32 v33, v33, v41
v_add_f32 v34, v34, v42
v_add_f32 v35, v35, v43
v_add_f32 v36, v36, v44
v_add_f32 v37, v37, v45
v_add_f32 v38, v38, v46
v_add_f32 v39, v39, v47
v_add_f32_dpp v32, v32, v32 quad_perm:[1,0,3,2] row_mask:0xf bank_mask:0xf
v_add_f32_dpp v33, v33, v33 quad_perm:[1,0,3,2] row_mask:0xf bank_mask:0xf
v_add_f32_dpp v34, v34, v34 quad_perm:[1,0,3,2] row_mask:0xf bank_mask:0xf
v_add_f32_dpp v35, v35, v35 quad_perm:[1,0,3,2] row_mask:0xf bank_mask:0xf
v_add_f32_dpp v36, v36, v36 quad_perm:[1,0,3,2] row_mask:0xf bank_mask:0xf
v_add_f32_dpp v37, v37, v37 quad_perm:[1,0,3,2] row_mask:0xf bank_mask:0xf
v_add_f32_dpp v38, v38, v38 quad_perm:[1,0,3,2] row_mask:0xf bank_mask:0xf
v_add_f32_dpp v39, v39, v39 quad_perm:[1,0,3,2] row_mask:0xf bank_mask:0xf
v_add_f32_dpp v32, v32, v32 quad_perm:[2,3,0,1] row_mask:0xf bank_mask:0xf
v_add_f32_dpp v33, v33, v33 quad_perm:[2,3,0,1] row_mask:0xf bank_mask:0xf
v_add_f32_dpp v34, v34, v34 quad_perm:[2,3,0,1] row_mask:0xf bank_mask:0xf
v_add_f32_dpp v35, v35, v35 quad_perm:[2,3,0,1] row_mask:0xf bank_mask:0xf
v_add_f32_dpp v36, v36, v36 quad_perm:[2,3,0,1] row_mask:0xf bank_mask:0xf
v_add_f32_dpp v37, v37, v37 quad_perm:[2,3,0,1] row_mask:0xf bank_mask:0xf
v_add_f32_dpp v38, v38, v38 quad_perm:[2,3,0,1] row_mask:0xf bank_mask:0xf
v_add_f32_dpp v39, v39, v39 quad_perm:[2,3,0,1] row_mask:0xf bank_mask:0xf
v_add_f32_dpp v32, v32, v32 row_half_mirror row_mask:0xf bank_mask:0xf
v_add_f32_dpp v33, v33, v33 row_half_mirror row_mask:0xf bank_mask:0xf
v_add_f32_dpp v34, v34, v34 row_half_mirror row_mask:0xf bank_mask:0xf
v_add_f32_dpp v35, v35, v35 row_half_mirror row_mask:0xf bank_mask:0xf
v_add_f32_dpp v36, v36, v36 row_half_mirror row_mask:0xf bank_mask:0xf
v_add_f32_dpp v37, v37, v37 row_half_mirror row_mask:0xf bank_mask:0xf
v_add_f32_dpp v38, v38, v38 row_half_mirror row_mask:0xf bank_mask:0xf
v_add_f32_dpp v39, v39, v39 row_half_mirror row_mask:0xf bank_mask:0xf
v_mul_f32 v36, 0x3b000000, v36
v_mul_f32 v32, 0x3b000000, v32
v_mul_f32 v37, 0x3b000000, v37
v_mul_f32 v33, 0x3b000000, v33
v_mul_f32 v38, 0x3b000000, v38
v_mul_f32 v34, 0x3b000000, v34
v_mul_f32 v39, 0x3b000000, v39
v_mul_f32 v35, 0x3b000000, v35
v_fma_f32 v32, -v36, v36, v32
v_fma_f32 v33, -v37, v37, v33
v_fma_f32 v34, -v38, v38, v34
v_fma_f32 v35, -v39, v39, v35
v_max_f32 v32, 0, v32
v_max_f32 v33, 0, v33
v_max_f32 v34, 0, v34
v_max_f32 v35, 0, v35
v_add_f32 v32, 0x3727c5ac, v32
v_add_f32 v33, 0x3727c5ac, v33
v_add_f32 v34, 0x3727c5ac, v34
v_add_f32 v35, 0x3727c5ac, v35
v_rsq_f32 v22, v32
v_rsq_f32 v24, v33
v_rsq_f32 v26, v34
v_rsq_f32 v28, v35
v_mul_f32_e64 v23, -v36, v22
v_mul_f32_e64 v25, -v37, v24
v_mul_f32_e64 v27, -v38, v26
v_mul_f32_e64 v29, -v39, v28
s_cmp_lt_u32 s52, 4
s_cbranch_scc1 LC
v_pk_fma_f32 v[128:129], v[128:129], v[22:23], v[22:23] op_sel:[0,0,1] op_sel_hi:[1,0,1]
v_pk_fma_f32 v[130:131], v[130:131], v[22:23], v[22:23] op_sel:[0,0,1] op_sel_hi:[1,0,1]
v_pk_fma_f32 v[132:133], v[132:133], v[22:23], v[22:23] op_sel:[0,0,1] op_sel_hi:[1,0,1]
v_pk_fma_f32 v[134:135], v[134:135], v[22:23], v[22:23] op_sel:[0,0,1] op_sel_hi:[1,0,1]
v_cvt_pk_bf16_f32 v64, v128, v129
v_cvt_pk_bf16_f32 v65, v130, v131
v_cvt_pk_bf16_f32 v66, v132, v133
v_cvt_pk_bf16_f32 v67, v134, v135
ds_write_b128 v12, v[64:67] offset:0
s_cmp_lg_u32 s48, 2
s_cbranch_scc1 Lwm1
v_min_u32 v5, 42, v0
v_lshlrev_b32 v5, 7, v5
s_mul_i32 s54, s2, 5504
buffer_load_dword v31, v5, s[24:27], s54 offen
Lwm1:
v_pk_fma_f32 v[136:137], v[136:137], v[24:25], v[24:25] op_sel:[0,0,1] op_sel_hi:[1,0,1]
v_pk_fma_f32 v[138:139], v[138:139], v[24:25], v[24:25] op_sel:[0,0,1] op_sel_hi:[1,0,1]
v_pk_fma_f32 v[140:141], v[140:141], v[24:25], v[24:25] op_sel:[0,0,1] op_sel_hi:[1,0,1]
v_pk_fma_f32 v[142:143], v[142:143], v[24:25], v[24:25] op_sel:[0,0,1] op_sel_hi:[1,0,1]
v_cvt_pk_bf16_f32 v68, v136, v137
v_cvt_pk_bf16_f32 v69, v138, v139
v_cvt_pk_bf16_f32 v70, v140, v141
v_cvt_pk_bf16_f32 v71, v142, v143
ds_write_b128 v13, v[68:71] offset:1024
v_pk_fma_f32 v[144:145], v[144:145], v[26:27], v[26:27] op_sel:[0,0,1] op_sel_hi:[1,0,1]
v_pk_fma_f32 v[146:147], v[146:147], v[26:27], v[26:27] op_sel:[0,0,1] op_sel_hi:[1,0,1]
v_pk_fma_f32 v[148:149], v[148:149], v[26:27], v[26:27] op_sel:[0,0,1] op_sel_hi:[1,0,1]
v_pk_fma_f32 v[150:151], v[150:151], v[26:27], v[26:27] op_sel:[0,0,1] op_sel_hi:[1,0,1]
v_cvt_pk_bf16_f32 v72, v144, v145
v_cvt_pk_bf16_f32 v73, v146, v147
v_cvt_pk_bf16_f32 v74, v148, v149
v_cvt_pk_bf16_f32 v75, v150, v151
ds_write_b128 v12, v[72:75] offset:2048
v_pk_fma_f32 v[152:153], v[152:153], v[28:29], v[28:29] op_sel:[0,0,1] op_sel_hi:[1,0,1]
v_pk_fma_f32 v[154:155], v[154:155], v[28:29], v[28:29] op_sel:[0,0,1] op_sel_hi:[1,0,1]
v_pk_fma_f32 v[156:157], v[156:157], v[28:29], v[28:29] op_sel:[0,0,1] op_sel_hi:[1,0,1]
v_pk_fma_f32 v[158:159], v[158:159], v[28:29], v[28:29] op_sel:[0,0,1] op_sel_hi:[1,0,1]
v_cvt_pk_bf16_f32 v76, v152, v153
v_cvt_pk_bf16_f32 v77, v154, v155
v_cvt_pk_bf16_f32 v78, v156, v157
v_cvt_pk_bf16_f32 v79, v158, v159
ds_write_b128 v13, v[76:79] offset:3072
v_pk_fma_f32 v[160:161], v[160:161], v[22:23], v[22:23] op_sel:[0,0,1] op_sel_hi:[1,0,1]
v_pk_fma_f32 v[162:163], v[162:163], v[22:23], v[22:23] op_sel:[0,0,1] op_sel_hi:[1,0,1]
v_pk_fma_f32 v[164:165], v[164:165], v[22:23], v[22:23] op_sel:[0,0,1] op_sel_hi:[1,0,1]
v_pk_fma_f32 v[166:167], v[166:167], v[22:23], v[22:23] op_sel:[0,0,1] op_sel_hi:[1,0,1]
v_cvt_pk_bf16_f32 v80, v160, v161
v_cvt_pk_bf16_f32 v81, v162, v163
v_cvt_pk_bf16_f32 v82, v164, v165
v_cvt_pk_bf16_f32 v83, v166, v167
ds_write_b128 v12, v[80:83] offset:16384
v_pk_fma_f32 v[168:169], v[168:169], v[24:25], v[24:25] op_sel:[0,0,1] op_sel_hi:[1,0,1]
v_pk_fma_f32 v[170:171], v[170:171], v[24:25], v[24:25] op_sel:[0,0,1] op_sel_hi:[1,0,1]
v_pk_fma_f32 v[172:173], v[172:173], v[24:25], v[24:25] op_sel:[0,0,1] op_sel_hi:[1,0,1]
v_pk_fma_f32 v[174:175], v[174:175], v[24:25], v[24:25] op_sel:[0,0,1] op_sel_hi:[1,0,1]
v_cvt_pk_bf16_f32 v84, v168, v169
v_cvt_pk_bf16_f32 v85, v170, v171
v_cvt_pk_bf16_f32 v86, v172, v173
v_cvt_pk_bf16_f32 v87, v174, v175
ds_write_b128 v13, v[84:87] offset:17408
v_pk_fma_f32 v[176:177], v[176:177], v[26:27], v[26:27] op_sel:[0,0,1] op_sel_hi:[1,0,1]
v_pk_fma_f32 v[178:179], v[178:179], v[26:27], v[26:27] op_sel:[0,0,1] op_sel_hi:[1,0,1]
v_pk_fma_f32 v[180:181], v[180:181], v[26:27], v[26:27] op_sel:[0,0,1] op_sel_hi:[1,0,1]
v_pk_fma_f32 v[182:183], v[182:183], v[26:27], v[26:27] op_sel:[0,0,1] op_sel_hi:[1,0,1]
v_cvt_pk_bf16_f32 v88, v176, v177
v_cvt_pk_bf16_f32 v89, v178, v179
v_cvt_pk_bf16_f32 v90, v180, v181
v_cvt_pk_bf16_f32 v91, v182, v183
ds_write_b128 v12, v[88:91] offset:18432
v_pk_fma_f32 v[184:185], v[184:185], v[28:29], v[28:29] op_sel:[0,0,1] op_sel_hi:[1,0,1]
v_pk_fma_f32 v[186:187], v[186:187], v[28:29], v[28:29] op_sel:[0,0,1] op_sel_hi:[1,0,1]
v_pk_fma_f32 v[188:189], v[188:189], v[28:29], v[28:29] op_sel:[0,0,1] op_sel_hi:[1,0,1]
v_pk_fma_f32 v[190:191], v[190:191], v[28:29], v[28:29] op_sel:[0,0,1] op_sel_hi:[1,0,1]
v_cvt_pk_bf16_f32 v92, v184, v185
v_cvt_pk_bf16_f32 v93, v186, v187
v_cvt_pk_bf16_f32 v94, v188, v189
v_cvt_pk_bf16_f32 v95, v190, v191
ds_write_b128 v13, v[92:95] offset:19456
v_pk_fma_f32 v[192:193], v[192:193], v[22:23], v[22:23] op_sel:[0,0,1] op_sel_hi:[1,0,1]
v_pk_fma_f32 v[194:195], v[194:195], v[22:23], v[22:23] op_sel:[0,0,1] op_sel_hi:[1,0,1]
v_pk_fma_f32 v[196:197], v[196:197], v[22:23], v[22:23] op_sel:[0,0,1] op_sel_hi:[1,0,1]
v_pk_fma_f32 v[198:199], v[198:199], v[22:23], v[22:23] op_sel:[0,0,1] op_sel_hi:[1,0,1]
v_cvt_pk_bf16_f32 v96, v192, v193
v_cvt_pk_bf16_f32 v97, v194, v195
v_cvt_pk_bf16_f32 v98, v196, v197
v_cvt_pk_bf16_f32 v99, v198, v199
ds_write_b128 v12, v[96:99] offset:32768
s_add_u32 s67, s51, 1
s_and_b32 s67, s67, 7
s_mul_i32 s67, s67, 176128
s_add_u32 s67, s67, s58
s_add_u32 m0, s74, 90112
s_nop 0
buffer_load_dwordx4 v18, s[16:19], s67 offen offset:0 lds
v_pk_fma_f32 v[200:201], v[200:201], v[24:25], v[24:25] op_sel:[0,0,1] op_sel_hi:[1,0,1]
v_pk_fma_f32 v[202:203], v[202:203], v[24:25], v[24:25] op_sel:[0,0,1] op_sel_hi:[1,0,1]
v_pk_fma_f32 v[204:205], v[204:205], v[24:25], v[24:25] op_sel:[0,0,1] op_sel_hi:[1,0,1]
v_pk_fma_f32 v[206:207], v[206:207], v[24:25], v[24:25] op_sel:[0,0,1] op_sel_hi:[1,0,1]
v_cvt_pk_bf16_f32 v100, v200, v201
v_cvt_pk_bf16_f32 v101, v202, v203
v_cvt_pk_bf16_f32 v102, v204, v205
v_cvt_pk_bf16_f32 v103, v206, v207
ds_write_b128 v13, v[100:103] offset:33792
s_add_u32 m0, s74, 91072
s_nop 0
buffer_load_dwordx4 v18, s[16:19], s67 offen offset:64 lds
v_pk_fma_f32 v[208:209], v[208:209], v[26:27], v[26:27] op_sel:[0,0,1] op_sel_hi:[1,0,1]
v_pk_fma_f32 v[210:211], v[210:211], v[26:27], v[26:27] op_sel:[0,0,1] op_sel_hi:[1,0,1]
v_pk_fma_f32 v[212:213], v[212:213], v[26:27], v[26:27] op_sel:[0,0,1] op_sel_hi:[1,0,1]
v_pk_fma_f32 v[214:215], v[214:215], v[26:27], v[26:27] op_sel:[0,0,1] op_sel_hi:[1,0,1]
v_cvt_pk_bf16_f32 v104, v208, v209
v_cvt_pk_bf16_f32 v105, v210, v211
v_cvt_pk_bf16_f32 v106, v212, v213
v_cvt_pk_bf16_f32 v107, v214, v215
ds_write_b128 v12, v[104:107] offset:34816
s_add_u32 m0, s74, 92032
s_nop 0
buffer_load_dwordx4 v18, s[16:19], s67 offen offset:128 lds
v_pk_fma_f32 v[216:217], v[216:217], v[28:29], v[28:29] op_sel:[0,0,1] op_sel_hi:[1,0,1]
v_pk_fma_f32 v[218:219], v[218:219], v[28:29], v[28:29] op_sel:[0,0,1] op_sel_hi:[1,0,1]
v_pk_fma_f32 v[220:221], v[220:221], v[28:29], v[28:29] op_sel:[0,0,1] op_sel_hi:[1,0,1]
v_pk_fma_f32 v[222:223], v[222:223], v[28:29], v[28:29] op_sel:[0,0,1] op_sel_hi:[1,0,1]
v_cvt_pk_bf16_f32 v108, v216, v217
v_cvt_pk_bf16_f32 v109, v218, v219
v_cvt_pk_bf16_f32 v110, v220, v221
v_cvt_pk_bf16_f32 v111, v222, v223
ds_write_b128 v13, v[108:111] offset:35840
s_add_u32 m0, s74, 93184
s_nop 0
buffer_load_dwordx4 v18, s[20:23], s67 offen offset:0 lds
v_pk_fma_f32 v[224:225], v[224:225], v[22:23], v[22:23] op_sel:[0,0,1] op_sel_hi:[1,0,1]
v_pk_fma_f32 v[226:227], v[226:227], v[22:23], v[22:23] op_sel:[0,0,1] op_sel_hi:[1,0,1]
v_pk_fma_f32 v[228:229], v[228:229], v[22:23], v[22:23] op_sel:[0,0,1] op_sel_hi:[1,0,1]
v_pk_fma_f32 v[230:231], v[230:231], v[22:23], v[22:23] op_sel:[0,0,1] op_sel_hi:[1,0,1]
v_cvt_pk_bf16_f32 v112, v224, v225
v_cvt_pk_bf16_f32 v113, v226, v227
v_cvt_pk_bf16_f32 v114, v228, v229
v_cvt_pk_bf16_f32 v115, v230, v231
ds_write_b128 v12, v[112:115] offset:49152
s_add_u32 m0, s74, 94144
s_nop 0
buffer_load_dwordx4 v18, s[20:23], s67 offen offset:64 lds
v_pk_fma_f32 v[232:233], v[232:233], v[24:25], v[24:25] op_sel:[0,0,1] op_sel_hi:[1,0,1]
v_pk_fma_f32 v[234:235], v[234:235], v[24:25], v[24:25] op_sel:[0,0,1] op_sel_hi:[1,0,1]
v_pk_fma_f32 v[236:237], v[236:237], v[24:25], v[24:25] op_sel:[0,0,1] op_sel_hi:[1,0,1]
v_pk_fma_f32 v[238:239], v[238:239], v[24:25], v[24:25] op_sel:[0,0,1] op_sel_hi:[1,0,1]
v_cvt_pk_bf16_f32 v116, v232, v233
v_cvt_pk_bf16_f32 v117, v234, v235
v_cvt_pk_bf16_f32 v118, v236, v237
v_cvt_pk_bf16_f32 v119, v238, v239
ds_write_b128 v13, v[116:119] offset:50176
s_add_u32 m0, s74, 95104
s_nop 0
buffer_load_dwordx4 v18, s[20:23], s67 offen offset:128 lds
v_pk_fma_f32 v[240:241], v[240:241], v[26:27], v[26:27] op_sel:[0,0,1] op_sel_hi:[1,0,1]
v_pk_fma_f32 v[242:243], v[242:243], v[26:27], v[26:27] op_sel:[0,0,1] op_sel_hi:[1,0,1]
v_pk_fma_f32 v[244:245], v[244:245], v[26:27], v[26:27] op_sel:[0,0,1] op_sel_hi:[1,0,1]
v_pk_fma_f32 v[246:247], v[246:247], v[26:27], v[26:27] op_sel:[0,0,1] op_sel_hi:[1,0,1]
v_cvt_pk_bf16_f32 v120, v240, v241
v_cvt_pk_bf16_f32 v121, v242, v243
v_cvt_pk_bf16_f32 v122, v244, v245
v_cvt_pk_bf16_f32 v123, v246, v247
ds_write_b128 v12, v[120:123] offset:51200
v_pk_fma_f32 v[248:249], v[248:249], v[28:29], v[28:29] op_sel:[0,0,1] op_sel_hi:[1,0,1]
v_pk_fma_f32 v[250:251], v[250:251], v[28:29], v[28:29] op_sel:[0,0,1] op_sel_hi:[1,0,1]
v_pk_fma_f32 v[252:253], v[252:253], v[28:29], v[28:29] op_sel:[0,0,1] op_sel_hi:[1,0,1]
v_pk_fma_f32 v[254:255], v[254:255], v[28:29], v[28:29] op_sel:[0,0,1] op_sel_hi:[1,0,1]
v_cvt_pk_bf16_f32 v124, v248, v249
v_cvt_pk_bf16_f32 v125, v250, v251
v_cvt_pk_bf16_f32 v126, v252, v253
v_cvt_pk_bf16_f32 v127, v254, v255
ds_write_b128 v13, v[124:127] offset:52224
s_waitcnt lgkmcnt(0)
s_barrier
s_and_b32 s60, s2, 7
s_lshl_b32 s60, s60, 2
s_lshr_b32 s9, s2, 6
s_add_u32 s60, s60, s9
s_lshl_b32 s62, s60, 1
s_add_u32 s62, s62, s61
s_and_b32 s62, s62, 7
s_mul_i32 s62, s62, 11
s_lshr_b32 s62, s62, 2
s_mul_i32 s71, s48, 360448
s_lshl_b32 s53, s61, 7
s_add_u32 s71, s71, s53
s_add_u32 s64, s71, 360448
s_lshl_b32 s47, s62, 14
s_add_u32 s47, s47, s71
s_add_u32 s67, s51, 2
s_and_b32 s67, s67, 7
s_mul_i32 s67, s67, 176128
s_add_u32 s67, s67, s58
s_add_u32 m0, s74, 114688
s_nop 0
buffer_load_dwordx4 v18, s[16:19], s67 offen offset:0 lds
s_add_u32 m0, s74, 115648
s_nop 0
buffer_load_dwordx4 v18, s[16:19], s67 offen offset:64 lds
s_add_u32 m0, s74, 116608
s_nop 0
buffer_load_dwordx4 v18, s[16:19], s67 offen offset:128 lds
s_add_u32 m0, s74, 117760
s_nop 0
buffer_load_dwordx4 v18, s[20:23], s67 offen offset:0 lds
s_add_u32 m0, s74, 118720
s_nop 0
buffer_load_dwordx4 v18, s[20:23], s67 offen offset:64 lds
s_add_u32 m0, s74, 119680
s_nop 0
buffer_load_dwordx4 v18, s[20:23], s67 offen offset:128 lds
s_waitcnt vmcnt(6)
s_waitcnt lgkmcnt(0)
s_barrier
s_add_u32 s67, s51, 3
s_and_b32 s67, s67, 7
s_mul_i32 s67, s67, 176128
s_add_u32 s67, s67, s58
s_add_u32 m0, s74, 139264
s_nop 0
buffer_load_dwordx4 v18, s[16:19], s67 offen offset:0 lds
s_add_u32 m0, s74, 140224
s_nop 0
buffer_load_dwordx4 v18, s[16:19], s67 offen offset:64 lds
s_add_u32 m0, s74, 141184
s_nop 0
buffer_load_dwordx4 v18, s[16:19], s67 offen offset:128 lds
s_add_u32 m0, s74, 142336
s_nop 0
buffer_load_dwordx4 v18, s[20:23], s67 offen offset:0 lds
s_add_u32 m0, s74, 143296
s_nop 0
buffer_load_dwordx4 v18, s[20:23], s67 offen offset:64 lds
s_add_u32 m0, s74, 144256
s_nop 0
buffer_load_dwordx4 v18, s[20:23], s67 offen offset:128 lds
v_min_u32 v5, 42, v0
v_lshlrev_b32 v5, 7, v5
s_lshr_b32 s54, s2, 3
s_lshl_b32 s54, s54, 2
s_add_u32 s54, s54, s48
s_mul_i32 s54, s54, 11008
s_add_u32 s54, s54, 0
buffer_load_dword v31, v5, s[24:27], s54 offen
s_waitcnt vmcnt(7)
s_waitcnt lgkmcnt(0)
s_barrier
s_add_u32 s67, s51, 4
s_and_b32 s67, s67, 7
s_mul_i32 s67, s67, 176128
s_add_u32 s67, s67, s58
s_add_u32 m0, s74, 65536
s_nop 0
buffer_load_dwordx4 v18, s[16:19], s67 offen offset:0 lds
s_add_u32 m0, s74, 66496
s_nop 0
buffer_load_dwordx4 v18, s[16:19], s67 offen offset:64 lds
s_add_u32 m0, s74, 67456
s_nop 0
buffer_load_dwordx4 v18, s[16:19], s67 offen offset:128 lds
s_add_u32 m0, s74, 68608
s_nop 0
buffer_load_dwordx4 v18, s[20:23], s67 offen offset:0 lds
s_add_u32 m0, s74, 69568
s_nop 0
buffer_load_dwordx4 v18, s[20:23], s67 offen offset:64 lds
s_add_u32 m0, s74, 70528
s_nop 0
buffer_load_dwordx4 v18, s[20:23], s67 offen offset:128 lds
s_waitcnt vmcnt(7)
s_waitcnt lgkmcnt(0)
s_barrier
s_add_u32 s67, s51, 5
s_and_b32 s67, s67, 7
s_mul_i32 s67, s67, 176128
s_add_u32 s67, s67, s58
s_add_u32 m0, s74, 90112
s_nop 0
buffer_load_dwordx4 v18, s[16:19], s67 offen offset:0 lds
s_add_u32 m0, s74, 91072
s_nop 0
buffer_load_dwordx4 v18, s[16:19], s67 offen offset:64 lds
s_add_u32 m0, s74, 92032
s_nop 0
buffer_load_dwordx4 v18, s[16:19], s67 offen offset:128 lds
s_add_u32 m0, s74, 93184
s_nop 0
buffer_load_dwordx4 v18, s[20:23], s67 offen offset:0 lds
s_add_u32 m0, s74, 94144
s_nop 0
buffer_load_dwordx4 v18, s[20:23], s67 offen offset:64 lds
s_add_u32 m0, s74, 95104
s_nop 0
buffer_load_dwordx4 v18, s[20:23], s67 offen offset:128 lds
v_min_u32 v5, 42, v0
v_lshlrev_b32 v5, 7, v5
s_lshr_b32 s54, s2, 3
s_lshl_b32 s54, s54, 2
s_add_u32 s54, s54, s48
s_mul_i32 s54, s54, 11008
s_add_u32 s54, s54, 5504
buffer_load_dword v31, v5, s[24:27], s54 offen
s_waitcnt vmcnt(7)
s_waitcnt lgkmcnt(0)
s_barrier
s_add_u32 s67, s51, 6
s_and_b32 s67, s67, 7
s_mul_i32 s67, s67, 176128
s_add_u32 s67, s67, s58
s_add_u32 m0, s74, 114688
s_nop 0
buffer_load_dwordx4 v18, s[16:19], s67 offen offset:0 lds
s_add_u32 m0, s74, 115648
s_nop 0
buffer_load_dwordx4 v18, s[16:19], s67 offen offset:64 lds
s_add_u32 m0, s74, 116608
s_nop 0
buffer_load_dwordx4 v18, s[16:19], s67 offen offset:128 lds
s_add_u32 m0, s74, 117760
s_nop 0
buffer_load_dwordx4 v18, s[20:23], s67 offen offset:0 lds
s_add_u32 m0, s74, 118720
s_nop 0
buffer_load_dwordx4 v18, s[20:23], s67 offen offset:64 lds
s_add_u32 m0, s74, 119680
s_nop 0
buffer_load_dwordx4 v18, s[20:23], s67 offen offset:128 lds
s_waitcnt vmcnt(7)
s_waitcnt lgkmcnt(0)
s_barrier
s_add_u32 s67, s51, 7
s_and_b32 s67, s67, 7
s_mul_i32 s67, s67, 176128
s_add_u32 s67, s67, s58
s_add_u32 m0, s74, 139264
s_nop 0
buffer_load_dwordx4 v18, s[16:19], s67 offen offset:0 lds
s_add_u32 m0, s74, 140224
s_nop 0
buffer_load_dwordx4 v18, s[16:19], s67 offen offset:64 lds
s_add_u32 m0, s74, 141184
s_nop 0
buffer_load_dwordx4 v18, s[16:19], s67 offen offset:128 lds
s_add_u32 m0, s74, 142336
s_nop 0
buffer_load_dwordx4 v18, s[20:23], s67 offen offset:0 lds
s_add_u32 m0, s74, 143296
s_nop 0
buffer_load_dwordx4 v18, s[20:23], s67 offen offset:64 lds
s_add_u32 m0, s74, 144256
s_nop 0
buffer_load_dwordx4 v18, s[20:23], s67 offen offset:128 lds
s_add_u32 m0, s46, 0
s_add_u32 s53, s47, 16384
buffer_load_dwordx4 v20, s[24:27], s47 offen lds
s_add_u32 m0, s46, 960
s_add_u32 s53, s47, 16384
buffer_load_dwordx4 v20, s[24:27], s47 offen offset:64 lds
s_cmp_ge_u32 s53, s64
s_cselect_b32 s47, s71, s53
s_add_u32 m0, s46, 2048
s_add_u32 s53, s47, 16384
buffer_load_dwordx4 v20, s[24:27], s47 offen lds
s_add_u32 m0, s46, 3008
s_add_u32 s53, s47, 16384
buffer_load_dwordx4 v20, s[24:27], s47 offen offset:64 lds
s_cmp_ge_u32 s53, s64
s_cselect_b32 s47, s71, s53
v_mov_b32 v15, 14336
v_mov_b32 v32, 0
v_mov_b32 v33, 0
v_mov_b32 v34, 0
v_mov_b32_e64 v35, 0
ds_write_b128 v15, v[32:35]
s_waitcnt vmcnt(10)
s_waitcnt lgkmcnt(0)
s_barrier
s_add_u32 m0, s46, 4096
s_add_u32 s53, s47, 16384
buffer_load_dwordx4 v20, s[24:27], s47 offen lds
s_add_u32 m0, s46, 5056
s_add_u32 s53, s47, 16384
buffer_load_dwordx4 v20, s[24:27], s47 offen offset:64 lds
s_cmp_ge_u32 s53, s64
s_cselect_b32 s47, s71, s53
s_add_u32 m0, s46, 6144
s_add_u32 s53, s47, 16384
buffer_load_dwordx4 v20, s[24:27], s47 offen lds
s_add_u32 m0, s46, 7104
s_add_u32 s53, s47, 16384
buffer_load_dwordx4 v20, s[24:27], s47 offen offset:64 lds
s_cmp_ge_u32 s53, s64
s_cselect_b32 s47, s71, s53
s_add_u32 m0, s46, 8192
s_add_u32 s53, s47, 16384
buffer_load_dwordx4 v20, s[24:27], s47 offen lds
s_add_u32 m0, s46, 9152
s_add_u32 s53, s47, 16384
buffer_load_dwordx4 v20, s[24:27], s47 offen offset:64 lds
s_cmp_ge_u32 s53, s64
s_cselect_b32 s47, s71, s53
s_add_u32 m0, s46, 10240
s_add_u32 s53, s47, 16384
buffer_load_dwordx4 v20, s[24:27], s47 offen lds
s_add_u32 m0, s46, 11200
s_add_u32 s53, s47, 16384
buffer_load_dwordx4 v20, s[24:27], s47 offen offset:64 lds
s_cmp_ge_u32 s53, s64
s_cselect_b32 s47, s71, s53
s_add_u32 m0, s46, 12288
s_add_u32 s53, s47, 16384
buffer_load_dwordx4 v20, s[24:27], s47 offen lds
s_add_u32 m0, s46, 13248
s_add_u32 s53, s47, 16384
buffer_load_dwordx4 v20, s[24:27], s47 offen offset:64 lds
s_cmp_ge_u32 s53, s64
s_cselect_b32 s47, s71, s53
s_waitcnt vmcnt(14)
s_waitcnt lgkmcnt(0)
s_barrier
s_add_u32 m0, s74, 65536
s_add_u32 s53, s47, 16384
buffer_load_dwordx4 v20, s[24:27], s47 offen lds
s_add_u32 m0, s74, 66496
s_add_u32 s53, s47, 16384
buffer_load_dwordx4 v20, s[24:27], s47 offen offset:64 lds
s_cmp_ge_u32 s53, s64
s_cselect_b32 s47, s71, s53
s_add_u32 m0, s74, 67584
s_add_u32 s53, s47, 16384
buffer_load_dwordx4 v20, s[24:27], s47 offen lds
s_add_u32 m0, s74, 68544
s_add_u32 s53, s47, 16384
buffer_load_dwordx4 v20, s[24:27], s47 offen offset:64 lds
s_cmp_ge_u32 s53, s64
s_cselect_b32 s47, s71, s53
s_add_u32 m0, s74, 69632
s_add_u32 s53, s47, 16384
buffer_load_dwordx4 v20, s[24:27], s47 offen lds
s_add_u32 m0, s74, 70592
s_add_u32 s53, s47, 16384
buffer_load_dwordx4 v20, s[24:27], s47 offen offset:64 lds
s_cmp_ge_u32 s53, s64
s_cselect_b32 s47, s71, s53
s_add_u32 m0, s74, 90112
s_add_u32 s53, s47, 16384
buffer_load_dwordx4 v20, s[24:27], s47 offen lds
s_add_u32 m0, s74, 91072
s_add_u32 s53, s47, 16384
buffer_load_dwordx4 v20, s[24:27], s47 offen offset:64 lds
s_cmp_ge_u32 s53, s64
s_cselect_b32 s47, s71, s53
s_add_u32 m0, s74, 92160
s_add_u32 s53, s47, 16384
buffer_load_dwordx4 v20, s[24:27], s47 offen lds
s_add_u32 m0, s74, 93120
s_add_u32 s53, s47, 16384
buffer_load_dwordx4 v20, s[24:27], s47 offen offset:64 lds
s_cmp_ge_u32 s53, s64
s_cselect_b32 s47, s71, s53
s_add_u32 m0, s74, 94208
s_add_u32 s53, s47, 16384
buffer_load_dwordx4 v20, s[24:27], s47 offen lds
s_add_u32 m0, s74, 95168
s_add_u32 s53, s47, 16384
buffer_load_dwordx4 v20, s[24:27], s47 offen offset:64 lds
s_cmp_ge_u32 s53, s64
s_cselect_b32 s47, s71, s53
s_mov_b32 s56, 0
LwG:
ds_read_b32 v4, v15 offset:12
s_waitcnt lgkmcnt(0)
v_readfirstlane_b32 s53, v4
s_add_u32 s56, s56, 1
s_cmp_ge_u32 s56, 0x800000
s_cbranch_scc1 LwGx
s_cmp_ge_u32 s53, 4
s_cbranch_scc1 LwGx
s_sleep 1
s_branch LwG
LwGx:
v_mov_b32 v30, 0
buffer_load_dword v31, v30, s[32:35], 0 offen sc1
s_branch LH2
LS:
s_cmp_lt_u32 s52, 4
s_cbranch_scc1 LCS
LHS:
s_setprio 1
v_lshl_add_u32 v14, v6, 7, v2
v_lshl_add_u32 v15, v6, 7, v3
v_add_u32 v14, s63, v14
v_add_u32 v15, s63, v15
s_add_u32 s53, s8, 4
s_and_b32 s53, s53, 7
s_lshl_b32 s53, s53, 7
s_add_u32 s53, s53, s57
buffer_load_dwordx4 v[192:195], v4, s[4:7], s53 offen
s_add_u32 s53, s53, 524288
buffer_load_dwordx4 v[196:199], v4, s[4:7], s53 offen
s_add_u32 s53, s53, 524288
buffer_load_dwordx4 v[200:203], v4, s[4:7], s53 offen
s_add_u32 s53, s53, 524288
buffer_load_dwordx4 v[204:207], v4, s[4:7], s53 offen
v_mov_b32 v32, 0
v_mov_b32 v33, 0
v_mov_b32 v34, 0
v_mov_b32 v35, 0
v_mov_b32 v36, 0
v_mov_b32 v37, 0
v_mov_b32 v38, 0
v_mov_b32 v39, 0
v_mov_b32 v40, 0
v_mov_b32 v41, 0
v_mov_b32 v42, 0
v_mov_b32 v43, 0
v_mov_b32 v44, 0
v_mov_b32 v45, 0
v_mov_b32 v46, 0
v_mov_b32 v47, 0
s_waitcnt vmcnt(8)
s_add_u32 s53, s8, 5
s_and_b32 s53, s53, 7
s_lshl_b32 s53, s53, 7
s_add_u32 s53, s53, s57
buffer_load_dwordx4 v[208:211], v4, s[4:7], s53 offen
s_add_u32 s53, s53, 524288
buffer_load_dwordx4 v[212:215], v4, s[4:7], s53 offen
s_add_u32 s53, s53, 524288
buffer_load_dwordx4 v[216:219], v4, s[4:7], s53 offen
s_add_u32 s53, s53, 524288
buffer_load_dwordx4 v[220:223], v4, s[4:7], s53 offen
v_dot2_f32_bf16 v32, v64, v64, v32
v_dot2_f32_bf16 v36, v64, s66, v36
v_dot2_f32_bf16 v33, v68, v68, v33
v_dot2_f32_bf16 v37, v68, s66, v37
v_dot2_f32_bf16 v34, v72, v72, v34
v_dot2_f32_bf16 v38, v72, s66, v38
v_dot2_f32_bf16 v35, v76, v76, v35
v_dot2_f32_bf16 v39, v76, s66, v39
v_dot2_f32_bf16 v40, v65, v65, v40
v_dot2_f32_bf16 v44, v65, s66, v44
v_dot2_f32_bf16 v41, v69, v69, v41
v_dot2_f32_bf16 v45, v69, s66, v45
v_dot2_f32_bf16 v42, v73, v73, v42
v_dot2_f32_bf16 v46, v73, s66, v46
v_dot2_f32_bf16 v43, v77, v77, v43
v_dot2_f32_bf16 v47, v77, s66, v47
v_dot2_f32_bf16 v32, v66, v66, v32
v_dot2_f32_bf16 v36, v66, s66, v36
v_dot2_f32_bf16 v33, v70, v70, v33
v_dot2_f32_bf16 v37, v70, s66, v37
v_dot2_f32_bf16 v34, v74, v74, v34
v_dot2_f32_bf16 v38, v74, s66, v38
v_dot2_f32_bf16 v35, v78, v78, v35
v_dot2_f32_bf16 v39, v78, s66, v39
v_dot2_f32_bf16 v40, v67, v67, v40
v_dot2_f32_bf16 v44, v67, s66, v44
v_dot2_f32_bf16 v41, v71, v71, v41
v_dot2_f32_bf16 v45, v71, s66, v45
v_dot2_f32_bf16 v42, v75, v75, v42
v_dot2_f32_bf16 v46, v75, s66, v46
v_dot2_f32_bf16 v43, v79, v79, v43
v_dot2_f32_bf16 v47, v79, s66, v47
s_waitcnt vmcnt(8)
s_add_u32 s53, s8, 2
s_and_b32 s53, s53, 7
s_lshl_b32 s53, s53, 7
s_add_u32 s53, s53, s57
buffer_load_dwordx4 v[160:163], v4, s[4:7], s53 offen
s_add_u32 s53, s53, 524288
buffer_load_dwordx4 v[164:167], v4, s[4:7], s53 offen
s_add_u32 s53, s53, 524288
buffer_load_dwordx4 v[168:171], v4, s[4:7], s53 offen
s_add_u32 s53, s53, 524288
buffer_load_dwordx4 v[172:175], v4, s[4:7], s53 offen
v_dot2_f32_bf16 v32, v80, v80, v32
v_dot2_f32_bf16 v36, v80, s66, v36
v_dot2_f32_bf16 v33, v84, v84, v33
v_dot2_f32_bf16 v37, v84, s66, v37
v_dot2_f32_bf16 v34, v88, v88, v34
v_dot2_f32_bf16 v38, v88, s66, v38
v_dot2_f32_bf16 v35, v92, v92, v35
v_dot2_f32_bf16 v39, v92, s66, v39
v_dot2_f32_bf16 v40, v81, v81, v40
v_dot2_f32_bf16 v44, v81, s66, v44
v_dot2_f32_bf16 v41, v85, v85, v41
v_dot2_f32_bf16 v45, v85, s66, v45
v_dot2_f32_bf16 v42, v89, v89, v42
v_dot2_f32_bf16 v46, v89, s66, v46
v_dot2_f32_bf16 v43, v93, v93, v43
v_dot2_f32_bf16 v47, v93, s66, v47
v_dot2_f32_bf16 v32, v82, v82, v32
v_dot2_f32_bf16 v36, v82, s66, v36
v_dot2_f32_bf16 v33, v86, v86, v33
v_dot2_f32_bf16 v37, v86, s66, v37
v_dot2_f32_bf16 v34, v90, v90, v34
v_dot2_f32_bf16 v38, v90, s66, v38
v_dot2_f32_bf16 v35, v94, v94, v35
v_dot2_f32_bf16 v39, v94, s66, v39
v_dot2_f32_bf16 v40, v83, v83, v40
v_dot2_f32_bf16 v44, v83, s66, v44
v_dot2_f32_bf16 v41, v87, v87, v41
v_dot2_f32_bf16 v45, v87, s66, v45
v_dot2_f32_bf16 v42, v91, v91, v42
v_dot2_f32_bf16 v46, v91, s66, v46
v_dot2_f32_bf16 v43, v95, v95, v43
v_dot2_f32_bf16 v47, v95, s66, v47
s_waitcnt vmcnt(8)
s_add_u32 s53, s8, 6
s_and_b32 s53, s53, 7
s_lshl_b32 s53, s53, 7
s_add_u32 s53, s53, s57
buffer_load_dwordx4 v[224:227], v4, s[4:7], s53 offen
s_add_u32 s53, s53, 524288
buffer_load_dwordx4 v[228:231], v4, s[4:7], s53 offen
s_add_u32 s53, s53, 524288
buffer_load_dwordx4 v[232:235], v4, s[4:7], s53 offen
s_add_u32 s53, s53, 524288
buffer_load_dwordx4 v[236:239], v4, s[4:7], s53 offen
v_dot2_f32_bf16 v32, v192, v192, v32
v_dot2_f32_bf16 v36, v192, s66, v36
v_dot2_f32_bf16 v33, v196, v196, v33
v_dot2_f32_bf16 v37, v196, s66, v37
v_dot2_f32_bf16 v34, v200, v200, v34
v_dot2_f32_bf16 v38, v200, s66, v38
v_dot2_f32_bf16 v35, v204, v204, v35
v_dot2_f32_bf16 v39, v204, s66, v39
v_dot2_f32_bf16 v40, v193, v193, v40
v_dot2_f32_bf16 v44, v193, s66, v44
v_dot2_f32_bf16 v41, v197, v197, v41
v_dot2_f32_bf16 v45, v197, s66, v45
v_dot2_f32_bf16 v42, v201, v201, v42
v_dot2_f32_bf16 v46, v201, s66, v46
v_dot2_f32_bf16 v43, v205, v205, v43
v_dot2_f32_bf16 v47, v205, s66, v47
v_dot2_f32_bf16 v32, v194, v194, v32
v_dot2_f32_bf16 v36, v194, s66, v36
v_dot2_f32_bf16 v33, v198, v198, v33
v_dot2_f32_bf16 v37, v198, s66, v37
v_dot2_f32_bf16 v34, v202, v202, v34
v_dot2_f32_bf16 v38, v202, s66, v38
v_dot2_f32_bf16 v35, v206, v206, v35
v_dot2_f32_bf16 v39, v206, s66, v39
v_dot2_f32_bf16 v40, v195, v195, v40
v_dot2_f32_bf16 v44, v195, s66, v44
v_dot2_f32_bf16 v41, v199, v199, v41
v_dot2_f32_bf16 v45, v199, s66, v45
v_dot2_f32_bf16 v42, v203, v203, v42
v_dot2_f32_bf16 v46, v203, s66, v46
v_dot2_f32_bf16 v43, v207, v207, v43
v_dot2_f32_bf16 v47, v207, s66, v47
s_waitcnt vmcnt(8)
s_add_u32 s53, s8, 3
s_and_b32 s53, s53, 7
s_lshl_b32 s53, s53, 7
s_add_u32 s53, s53, s57
buffer_load_dwordx4 v[176:179], v4, s[4:7], s53 offen
s_add_u32 s53, s53, 524288
buffer_load_dwordx4 v[180:183], v4, s[4:7], s53 offen
s_add_u32 s53, s53, 524288
buffer_load_dwordx4 v[184:187], v4, s[4:7], s53 offen
s_add_u32 s53, s53, 524288
buffer_load_dwordx4 v[188:191], v4, s[4:7], s53 offen
v_dot2_f32_bf16 v32, v208, v208, v32
v_dot2_f32_bf16 v36, v208, s66, v36
v_dot2_f32_bf16 v33, v212, v212, v33
v_dot2_f32_bf16 v37, v212, s66, v37
v_dot2_f32_bf16 v34, v216, v216, v34
v_dot2_f32_bf16 v38, v216, s66, v38
v_dot2_f32_bf16 v35, v220, v220, v35
v_dot2_f32_bf16 v39, v220, s66, v39
v_dot2_f32_bf16 v40, v209, v209, v40
v_dot2_f32_bf16 v44, v209, s66, v44
v_dot2_f32_bf16 v41, v213, v213, v41
v_dot2_f32_bf16 v45, v213, s66, v45
v_dot2_f32_bf16 v42, v217, v217, v42
v_dot2_f32_bf16 v46, v217, s66, v46
v_dot2_f32_bf16 v43, v221, v221, v43
v_dot2_f32_bf16 v47, v221, s66, v47
v_dot2_f32_bf16 v32, v210, v210, v32
v_dot2_f32_bf16 v36, v210, s66, v36
v_dot2_f32_bf16 v33, v214, v214, v33
v_dot2_f32_bf16 v37, v214, s66, v37
v_dot2_f32_bf16 v34, v218, v218, v34
v_dot2_f32_bf16 v38, v218, s66, v38
v_dot2_f32_bf16 v35, v222, v222, v35
v_dot2_f32_bf16 v39, v222, s66, v39
v_dot2_f32_bf16 v40, v211, v211, v40
v_dot2_f32_bf16 v44, v211, s66, v44
v_dot2_f32_bf16 v41, v215, v215, v41
v_dot2_f32_bf16 v45, v215, s66, v45
v_dot2_f32_bf16 v42, v219, v219, v42
v_dot2_f32_bf16 v46, v219, s66, v46
v_dot2_f32_bf16 v43, v223, v223, v43
v_dot2_f32_bf16 v47, v223, s66, v47
s_waitcnt vmcnt(8)
s_add_u32 s53, s8, 7
s_and_b32 s53, s53, 7
s_lshl_b32 s53, s53, 7
s_add_u32 s53, s53, s57
buffer_load_dwordx4 v[240:243], v4, s[4:7], s53 offen
s_add_u32 s53, s53, 524288
buffer_load_dwordx4 v[244:247], v4, s[4:7], s53 offen
s_add_u32 s53, s53, 524288
buffer_load_dwordx4 v[248:251], v4, s[4:7], s53 offen
s_add_u32 s53, s53, 524288
buffer_load_dwordx4 v[252:255], v4, s[4:7], s53 offen
v_dot2_f32_bf16 v32, v160, v160, v32
v_dot2_f32_bf16 v36, v160, s66, v36
v_dot2_f32_bf16 v33, v164, v164, v33
v_dot2_f32_bf16 v37, v164, s66, v37
v_dot2_f32_bf16 v34, v168, v168, v34
v_dot2_f32_bf16 v38, v168, s66, v38
v_dot2_f32_bf16 v35, v172, v172, v35
v_dot2_f32_bf16 v39, v172, s66, v39
v_dot2_f32_bf16 v40, v161, v161, v40
v_dot2_f32_bf16 v44, v161, s66, v44
v_dot2_f32_bf16 v41, v165, v165, v41
v_dot2_f32_bf16 v45, v165, s66, v45
v_dot2_f32_bf16 v42, v169, v169, v42
v_dot2_f32_bf16 v46, v169, s66, v46
v_dot2_f32_bf16 v43, v173, v173, v43
v_dot2_f32_bf16 v47, v173, s66, v47
v_dot2_f32_bf16 v32, v162, v162, v32
v_dot2_f32_bf16 v36, v162, s66, v36
v_dot2_f32_bf16 v33, v166, v166, v33
v_dot2_f32_bf16 v37, v166, s66, v37
v_dot2_f32_bf16 v34, v170, v170, v34
v_dot2_f32_bf16 v38, v170, s66, v38
v_dot2_f32_bf16 v35, v174, v174, v35
v_dot2_f32_bf16 v39, v174, s66, v39
v_dot2_f32_bf16 v40, v163, v163, v40
v_dot2_f32_bf16 v44, v163, s66, v44
v_dot2_f32_bf16 v41, v167, v167, v41
v_dot2_f32_bf16 v45, v167, s66, v45
v_dot2_f32_bf16 v42, v171, v171, v42
v_dot2_f32_bf16 v46, v171, s66, v46
v_dot2_f32_bf16 v43, v175, v175, v43
v_dot2_f32_bf16 v47, v175, s66, v47
s_waitcnt vmcnt(8)
v_dot2_f32_bf16 v32, v224, v224, v32
v_dot2_f32_bf16 v36, v224, s66, v36
v_dot2_f32_bf16 v33, v228, v228, v33
v_dot2_f32_bf16 v37, v228, s66, v37
v_dot2_f32_bf16 v34, v232, v232, v34
v_dot2_f32_bf16 v38, v232, s66, v38
v_dot2_f32_bf16 v35, v236, v236, v35
v_dot2_f32_bf16 v39, v236, s66, v39
v_dot2_f32_bf16 v40, v225, v225, v40
v_dot2_f32_bf16 v44, v225, s66, v44
v_dot2_f32_bf16 v41, v229, v229, v41
v_dot2_f32_bf16 v45, v229, s66, v45
v_dot2_f32_bf16 v42, v233, v233, v42
v_dot2_f32_bf16 v46, v233, s66, v46
v_dot2_f32_bf16 v43, v237, v237, v43
v_dot2_f32_bf16 v47, v237, s66, v47
v_dot2_f32_bf16 v32, v226, v226, v32
v_dot2_f32_bf16 v36, v226, s66, v36
v_dot2_f32_bf16 v33, v230, v230, v33
v_dot2_f32_bf16 v37, v230, s66, v37
v_dot2_f32_bf16 v34, v234, v234, v34
v_dot2_f32_bf16 v38, v234, s66, v38
v_dot2_f32_bf16 v35, v238, v238, v35
v_dot2_f32_bf16 v39, v238, s66, v39
v_dot2_f32_bf16 v40, v227, v227, v40
v_dot2_f32_bf16 v44, v227, s66, v44
v_dot2_f32_bf16 v41, v231, v231, v41
v_dot2_f32_bf16 v45, v231, s66, v45
v_dot2_f32_bf16 v42, v235, v235, v42
v_dot2_f32_bf16 v46, v235, s66, v46
v_dot2_f32_bf16 v43, v239, v239, v43
v_dot2_f32_bf16 v47, v239, s66, v47
s_waitcnt vmcnt(4)
v_dot2_f32_bf16 v32, v176, v176, v32
v_dot2_f32_bf16 v36, v176, s66, v36
v_dot2_f32_bf16 v33, v180, v180, v33
v_dot2_f32_bf16 v37, v180, s66, v37
v_dot2_f32_bf16 v34, v184, v184, v34
v_dot2_f32_bf16 v38, v184, s66, v38
v_dot2_f32_bf16 v35, v188, v188, v35
v_dot2_f32_bf16 v39, v188, s66, v39
v_dot2_f32_bf16 v40, v177, v177, v40
v_dot2_f32_bf16 v44, v177, s66, v44
v_dot2_f32_bf16 v41, v181, v181, v41
v_dot2_f32_bf16 v45, v181, s66, v45
v_dot2_f32_bf16 v42, v185, v185, v42
v_dot2_f32_bf16 v46, v185, s66, v46
v_dot2_f32_bf16 v43, v189, v189, v43
v_dot2_f32_bf16 v47, v189, s66, v47
v_dot2_f32_bf16 v32, v178, v178, v32
v_dot2_f32_bf16 v36, v178, s66, v36
v_dot2_f32_bf16 v33, v182, v182, v33
v_dot2_f32_bf16 v37, v182, s66, v37
v_dot2_f32_bf16 v34, v186, v186, v34
v_dot2_f32_bf16 v38, v186, s66, v38
v_dot2_f32_bf16 v35, v190, v190, v35
v_dot2_f32_bf16 v39, v190, s66, v39
v_dot2_f32_bf16 v40, v179, v179, v40
v_dot2_f32_bf16 v44, v179, s66, v44
v_dot2_f32_bf16 v41, v183, v183, v41
v_dot2_f32_bf16 v45, v183, s66, v45
v_dot2_f32_bf16 v42, v187, v187, v42
v_dot2_f32_bf16 v46, v187, s66, v46
v_dot2_f32_bf16 v43, v191, v191, v43
v_dot2_f32_bf16 v47, v191, s66, v47
s_waitcnt vmcnt(0)
v_dot2_f32_bf16 v32, v240, v240, v32
v_dot2_f32_bf16 v36, v240, s66, v36
v_dot2_f32_bf16 v33, v244, v244, v33
v_dot2_f32_bf16 v37, v244, s66, v37
v_dot2_f32_bf16 v34, v248, v248, v34
v_dot2_f32_bf16 v38, v248, s66, v38
v_dot2_f32_bf16 v35, v252, v252, v35
v_dot2_f32_bf16 v39, v252, s66, v39
v_dot2_f32_bf16 v40, v241, v241, v40
v_dot2_f32_bf16 v44, v241, s66, v44
v_dot2_f32_bf16 v41, v245, v245, v41
v_dot2_f32_bf16 v45, v245, s66, v45
v_dot2_f32_bf16 v42, v249, v249, v42
v_dot2_f32_bf16 v46, v249, s66, v46
v_dot2_f32_bf16 v43, v253, v253, v43
v_dot2_f32_bf16 v47, v253, s66, v47
v_dot2_f32_bf16 v32, v242, v242, v32
v_dot2_f32_bf16 v36, v242, s66, v36
v_dot2_f32_bf16 v33, v246, v246, v33
v_dot2_f32_bf16 v37, v246, s66, v37
v_dot2_f32_bf16 v34, v250, v250, v34
v_dot2_f32_bf16 v38, v250, s66, v38
v_dot2_f32_bf16 v35, v254, v254, v35
v_dot2_f32_bf16 v39, v254, s66, v39
v_dot2_f32_bf16 v40, v243, v243, v40
v_dot2_f32_bf16 v44, v243, s66, v44
v_dot2_f32_bf16 v41, v247, v247, v41
v_dot2_f32_bf16 v45, v247, s66, v45
v_dot2_f32_bf16 v42, v251, v251, v42
v_dot2_f32_bf16 v46, v251, s66, v46
v_dot2_f32_bf16 v43, v255, v255, v43
v_dot2_f32_bf16 v47, v255, s66, v47
s_nop 2
v_add_f32 v32, v32, v40
v_add_f32 v33, v33, v41
v_add_f32 v34, v34, v42
v_add_f32 v35, v35, v43
v_add_f32 v36, v36, v44
v_add_f32 v37, v37, v45
v_add_f32 v38, v38, v46
v_add_f32_e64 v39, v39, v47
v_add_f32_dpp v32, v32, v32 quad_perm:[1,0,3,2] row_mask:0xf bank_mask:0xf
v_add_f32_dpp v33, v33, v33 quad_perm:[1,0,3,2] row_mask:0xf bank_mask:0xf
v_add_f32_dpp v34, v34, v34 quad_perm:[1,0,3,2] row_mask:0xf bank_mask:0xf
v_add_f32_dpp v35, v35, v35 quad_perm:[1,0,3,2] row_mask:0xf bank_mask:0xf
v_add_f32_dpp v36, v36, v36 quad_perm:[1,0,3,2] row_mask:0xf bank_mask:0xf
v_add_f32_dpp v37, v37, v37 quad_perm:[1,0,3,2] row_mask:0xf bank_mask:0xf
v_add_f32_dpp v38, v38, v38 quad_perm:[1,0,3,2] row_mask:0xf bank_mask:0xf
v_add_f32_dpp v39, v39, v39 quad_perm:[1,0,3,2] row_mask:0xf bank_mask:0xf
v_add_f32_dpp v32, v32, v32 quad_perm:[2,3,0,1] row_mask:0xf bank_mask:0xf
v_add_f32_dpp v33, v33, v33 quad_perm:[2,3,0,1] row_mask:0xf bank_mask:0xf
v_add_f32_dpp v34, v34, v34 quad_perm:[2,3,0,1] row_mask:0xf bank_mask:0xf
v_add_f32_dpp v35, v35, v35 quad_perm:[2,3,0,1] row_mask:0xf bank_mask:0xf
v_add_f32_dpp v36, v36, v36 quad_perm:[2,3,0,1] row_mask:0xf bank_mask:0xf
v_add_f32_dpp v37, v37, v37 quad_perm:[2,3,0,1] row_mask:0xf bank_mask:0xf
v_add_f32_dpp v38, v38, v38 quad_perm:[2,3,0,1] row_mask:0xf bank_mask:0xf
v_add_f32_dpp v39, v39, v39 quad_perm:[2,3,0,1] row_mask:0xf bank_mask:0xf
v_add_f32_dpp v32, v32, v32 row_half_mirror row_mask:0xf bank_mask:0xf
v_add_f32_dpp v33, v33, v33 row_half_mirror row_mask:0xf bank_mask:0xf
v_add_f32_dpp v34, v34, v34 row_half_mirror row_mask:0xf bank_mask:0xf
v_add_f32_dpp v35, v35, v35 row_half_mirror row_mask:0xf bank_mask:0xf
v_add_f32_dpp v36, v36, v36 row_half_mirror row_mask:0xf bank_mask:0xf
v_add_f32_dpp v37, v37, v37 row_half_mirror row_mask:0xf bank_mask:0xf
v_add_f32_dpp v38, v38, v38 row_half_mirror row_mask:0xf bank_mask:0xf
v_add_f32_dpp v39, v39, v39 row_half_mirror row_mask:0xf bank_mask:0xf
v_mul_f32 v36, 0x3b000000, v36
v_mul_f32 v32, 0x3b000000, v32
v_mul_f32 v37, 0x3b000000, v37
v_mul_f32 v33, 0x3b000000, v33
v_mul_f32 v38, 0x3b000000, v38
v_mul_f32 v34, 0x3b000000, v34
v_mul_f32 v39, 0x3b000000, v39
v_mul_f32 v35, 0x3b000000, v35
v_fma_f32 v32, -v36, v36, v32
v_fma_f32 v33, -v37, v37, v33
v_fma_f32 v34, -v38, v38, v34
v_fma_f32 v35, -v39, v39, v35
v_max_f32 v32, 0, v32
v_max_f32 v33, 0, v33
v_max_f32 v34, 0, v34
v_max_f32 v35, 0, v35
v_add_f32 v32, 0x3727c5ac, v32
v_add_f32 v33, 0x3727c5ac, v33
v_add_f32 v34, 0x3727c5ac, v34
v_add_f32 v35, 0x3727c5ac, v35
v_rsq_f32 v22, v32
v_rsq_f32 v24, v33
v_rsq_f32 v26, v34
v_rsq_f32 v28, v35
v_mul_f32_e64 v23, -v36, v22
v_mul_f32_e64 v25, -v37, v24
v_mul_f32_e64 v27, -v38, v26
v_mul_f32_e64 v29, -v39, v28
s_cmp_lg_u32 s48, 2
s_cbranch_scc1 Lwm2
v_min_u32 v5, 42, v0
v_lshlrev_b32 v5, 7, v5
s_mul_i32 s54, s2, 5504
buffer_load_dword v31, v5, s[24:27], s54 offen
Lwm2:
v_add_u32 v14, 65536, v14
v_add_u32 v15, 65536, v15
s_bitcmp1_b32 s48, 0
s_cselect_b32 s40, s20, s16
s_cselect_b32 s41, s21, s17
s_mov_b32 s42, 1409024
s_mov_b32 s43, 0x20000
v_lshrrev_b32 v5, 1, v0
v_mul_u32_u24 v21, 2752, v5
v_and_b32_e64 v5, 1, v0
v_lshl_add_u32 v21, v5, 4, v21
s_lshr_b32 s70, s48, 1
s_mul_i32 s70, s70, 88064
s_lshl_b32 s53, s59, 5
s_add_u32 s70, s70, s53
s_add_u32 s70, s70, 2688
s_cmp_eq_u32 s59, 0
s_cselect_b32 s53, 1.0, -1.0
v_mov_b32 v48, s53
v_mov_b32 v49, s53
v_lshlrev_b32 v32, 16, v64
v_and_b32 v33, 0xffff0000, v64
v_lshlrev_b32_e64 v34, 16, v65
v_and_b32 v35, 0xffff0000, v65
v_lshlrev_b32_e64 v36, 16, v66
v_and_b32 v37, 0xffff0000, v66
v_lshlrev_b32_e64 v38, 16, v67
v_and_b32 v39, 0xffff0000, v67
v_pk_fma_f32 v[32:33], v[32:33], v[22:23], v[22:23] op_sel:[0,0,1] op_sel_hi:[1,0,1]
v_pk_fma_f32 v[34:35], v[34:35], v[22:23], v[22:23] op_sel:[0,0,1] op_sel_hi:[1,0,1]
v_pk_fma_f32 v[36:37], v[36:37], v[22:23], v[22:23] op_sel:[0,0,1] op_sel_hi:[1,0,1]
v_pk_fma_f32 v[38:39], v[38:39], v[22:23], v[22:23] op_sel:[0,0,1] op_sel_hi:[1,0,1]
v_cvt_pk_bf16_f32 v64, v32, v33
v_cvt_pk_bf16_f32 v65, v34, v35
v_cvt_pk_bf16_f32 v66, v36, v37
v_cvt_pk_bf16_f32 v67, v38, v39
v_lshlrev_b32_e64 v40, 16, v192
v_and_b32 v41, 0xffff0000, v192
v_lshlrev_b32_e64 v42, 16, v193
v_and_b32 v43, 0xffff0000, v193
v_lshlrev_b32_e64 v44, 16, v194
v_and_b32 v45, 0xffff0000, v194
v_lshlrev_b32_e64 v46, 16, v195
v_and_b32 v47, 0xffff0000, v195
v_pk_fma_f32 v[40:41], v[40:41], v[22:23], v[22:23] op_sel:[0,0,1] op_sel_hi:[1,0,1]
v_pk_fma_f32 v[42:43], v[42:43], v[22:23], v[22:23] op_sel:[0,0,1] op_sel_hi:[1,0,1]
v_pk_fma_f32 v[44:45], v[44:45], v[22:23], v[22:23] op_sel:[0,0,1] op_sel_hi:[1,0,1]
v_pk_fma_f32 v[46:47], v[46:47], v[22:23], v[22:23] op_sel:[0,0,1] op_sel_hi:[1,0,1]
v_cvt_pk_bf16_f32 v192, v40, v41
v_cvt_pk_bf16_f32 v193, v42, v43
v_cvt_pk_bf16_f32 v194, v44, v45
v_cvt_pk_bf16_f32 v195, v46, v47
v_pk_fma_f32 v[32:33], v[40:41], v[48:49], v[32:33]
v_pk_fma_f32 v[34:35], v[42:43], v[48:49], v[34:35]
v_pk_fma_f32 v[36:37], v[44:45], v[48:49], v[36:37]
v_pk_fma_f32 v[38:39], v[46:47], v[48:49], v[38:39]
v_cvt_pk_bf16_f32 v52, v32, v33
v_cvt_pk_bf16_f32 v53, v34, v35
v_cvt_pk_bf16_f32 v54, v36, v37
v_cvt_pk_bf16_f32 v55, v38, v39
ds_write_b128 v14, v[52:55] offset:0
s_add_u32 s53, s51, 0
s_and_b32 s53, s53, 7
s_mul_i32 s53, s53, 176128
s_add_u32 m0, s75, 131072
s_add_u32 s53, s53, s70
buffer_load_dwordx4 v21, s[40:43], s53 offen lds
v_lshlrev_b32 v32, 16, v68
v_and_b32 v33, 0xffff0000, v68
v_lshlrev_b32_e64 v34, 16, v69
v_and_b32 v35, 0xffff0000, v69
v_lshlrev_b32_e64 v36, 16, v70
v_and_b32 v37, 0xffff0000, v70
v_lshlrev_b32_e64 v38, 16, v71
v_and_b32 v39, 0xffff0000, v71
v_pk_fma_f32 v[32:33], v[32:33], v[24:25], v[24:25] op_sel:[0,0,1] op_sel_hi:[1,0,1]
v_pk_fma_f32 v[34:35], v[34:35], v[24:25], v[24:25] op_sel:[0,0,1] op_sel_hi:[1,0,1]
v_pk_fma_f32 v[36:37], v[36:37], v[24:25], v[24:25] op_sel:[0,0,1] op_sel_hi:[1,0,1]
v_pk_fma_f32 v[38:39], v[38:39], v[24:25], v[24:25] op_sel:[0,0,1] op_sel_hi:[1,0,1]
v_cvt_pk_bf16_f32 v68, v32, v33
v_cvt_pk_bf16_f32 v69, v34, v35
v_cvt_pk_bf16_f32 v70, v36, v37
v_cvt_pk_bf16_f32 v71, v38, v39
v_lshlrev_b32_e64 v40, 16, v196
v_and_b32 v41, 0xffff0000, v196
v_lshlrev_b32_e64 v42, 16, v197
v_and_b32 v43, 0xffff0000, v197
v_lshlrev_b32_e64 v44, 16, v198
v_and_b32 v45, 0xffff0000, v198
v_lshlrev_b32_e64 v46, 16, v199
v_and_b32 v47, 0xffff0000, v199
v_pk_fma_f32 v[40:41], v[40:41], v[24:25], v[24:25] op_sel:[0,0,1] op_sel_hi:[1,0,1]
v_pk_fma_f32 v[42:43], v[42:43], v[24:25], v[24:25] op_sel:[0,0,1] op_sel_hi:[1,0,1]
v_pk_fma_f32 v[44:45], v[44:45], v[24:25], v[24:25] op_sel:[0,0,1] op_sel_hi:[1,0,1]
v_pk_fma_f32 v[46:47], v[46:47], v[24:25], v[24:25] op_sel:[0,0,1] op_sel_hi:[1,0,1]
v_cvt_pk_bf16_f32 v196, v40, v41
v_cvt_pk_bf16_f32 v197, v42, v43
v_cvt_pk_bf16_f32 v198, v44, v45
v_cvt_pk_bf16_f32 v199, v46, v47
v_pk_fma_f32 v[32:33], v[40:41], v[48:49], v[32:33]
v_pk_fma_f32 v[34:35], v[42:43], v[48:49], v[34:35]
v_pk_fma_f32 v[36:37], v[44:45], v[48:49], v[36:37]
v_pk_fma_f32 v[38:39], v[46:47], v[48:49], v[38:39]
v_cvt_pk_bf16_f32 v56, v32, v33
v_cvt_pk_bf16_f32 v57, v34, v35
v_cvt_pk_bf16_f32 v58, v36, v37
v_cvt_pk_bf16_f32 v59, v38, v39
ds_write_b128 v15, v[56:59] offset:1024
s_add_u32 s53, s51, 4
s_and_b32 s53, s53, 7
s_mul_i32 s53, s53, 176128
s_add_u32 m0, s75, 135168
s_add_u32 s53, s53, s70
buffer_load_dwordx4 v21, s[40:43], s53 offen lds
v_lshlrev_b32 v32, 16, v72
v_and_b32 v33, 0xffff0000, v72
v_lshlrev_b32_e64 v34, 16, v73
v_and_b32 v35, 0xffff0000, v73
v_lshlrev_b32_e64 v36, 16, v74
v_and_b32 v37, 0xffff0000, v74
v_lshlrev_b32_e64 v38, 16, v75
v_and_b32 v39, 0xffff0000, v75
v_pk_fma_f32 v[32:33], v[32:33], v[26:27], v[26:27] op_sel:[0,0,1] op_sel_hi:[1,0,1]
v_pk_fma_f32 v[34:35], v[34:35], v[26:27], v[26:27] op_sel:[0,0,1] op_sel_hi:[1,0,1]
v_pk_fma_f32 v[36:37], v[36:37], v[26:27], v[26:27] op_sel:[0,0,1] op_sel_hi:[1,0,1]
v_pk_fma_f32 v[38:39], v[38:39], v[26:27], v[26:27] op_sel:[0,0,1] op_sel_hi:[1,0,1]
v_cvt_pk_bf16_f32 v72, v32, v33
v_cvt_pk_bf16_f32 v73, v34, v35
v_cvt_pk_bf16_f32 v74, v36, v37
v_cvt_pk_bf16_f32 v75, v38, v39
v_lshlrev_b32_e64 v40, 16, v200
v_and_b32 v41, 0xffff0000, v200
v_lshlrev_b32_e64 v42, 16, v201
v_and_b32 v43, 0xffff0000, v201
v_lshlrev_b32_e64 v44, 16, v202
v_and_b32 v45, 0xffff0000, v202
v_lshlrev_b32_e64 v46, 16, v203
v_and_b32 v47, 0xffff0000, v203
v_pk_fma_f32 v[40:41], v[40:41], v[26:27], v[26:27] op_sel:[0,0,1] op_sel_hi:[1,0,1]
v_pk_fma_f32 v[42:43], v[42:43], v[26:27], v[26:27] op_sel:[0,0,1] op_sel_hi:[1,0,1]
v_pk_fma_f32 v[44:45], v[44:45], v[26:27], v[26:27] op_sel:[0,0,1] op_sel_hi:[1,0,1]
v_pk_fma_f32 v[46:47], v[46:47], v[26:27], v[26:27] op_sel:[0,0,1] op_sel_hi:[1,0,1]
v_cvt_pk_bf16_f32 v200, v40, v41
v_cvt_pk_bf16_f32 v201, v42, v43
v_cvt_pk_bf16_f32 v202, v44, v45
v_cvt_pk_bf16_f32 v203, v46, v47
v_pk_fma_f32 v[32:33], v[40:41], v[48:49], v[32:33]
v_pk_fma_f32 v[34:35], v[42:43], v[48:49], v[34:35]
v_pk_fma_f32 v[36:37], v[44:45], v[48:49], v[36:37]
v_pk_fma_f32 v[38:39], v[46:47], v[48:49], v[38:39]
v_cvt_pk_bf16_f32 v52, v32, v33
v_cvt_pk_bf16_f32 v53, v34, v35
v_cvt_pk_bf16_f32 v54, v36, v37
v_cvt_pk_bf16_f32 v55, v38, v39
ds_write_b128 v14, v[52:55] offset:2048
s_add_u32 s53, s51, 1
s_and_b32 s53, s53, 7
s_mul_i32 s53, s53, 176128
s_add_u32 m0, s75, 132096
s_add_u32 s53, s53, s70
buffer_load_dwordx4 v21, s[40:43], s53 offen lds
v_lshlrev_b32 v32, 16, v76
v_and_b32 v33, 0xffff0000, v76
v_lshlrev_b32_e64 v34, 16, v77
v_and_b32 v35, 0xffff0000, v77
v_lshlrev_b32_e64 v36, 16, v78
v_and_b32 v37, 0xffff0000, v78
v_lshlrev_b32_e64 v38, 16, v79
v_and_b32 v39, 0xffff0000, v79
v_pk_fma_f32 v[32:33], v[32:33], v[28:29], v[28:29] op_sel:[0,0,1] op_sel_hi:[1,0,1]
v_pk_fma_f32 v[34:35], v[34:35], v[28:29], v[28:29] op_sel:[0,0,1] op_sel_hi:[1,0,1]
v_pk_fma_f32 v[36:37], v[36:37], v[28:29], v[28:29] op_sel:[0,0,1] op_sel_hi:[1,0,1]
v_pk_fma_f32 v[38:39], v[38:39], v[28:29], v[28:29] op_sel:[0,0,1] op_sel_hi:[1,0,1]
v_cvt_pk_bf16_f32 v76, v32, v33
v_cvt_pk_bf16_f32 v77, v34, v35
v_cvt_pk_bf16_f32 v78, v36, v37
v_cvt_pk_bf16_f32 v79, v38, v39
v_lshlrev_b32_e64 v40, 16, v204
v_and_b32 v41, 0xffff0000, v204
v_lshlrev_b32_e64 v42, 16, v205
v_and_b32 v43, 0xffff0000, v205
v_lshlrev_b32_e64 v44, 16, v206
v_and_b32 v45, 0xffff0000, v206
v_lshlrev_b32_e64 v46, 16, v207
v_and_b32 v47, 0xffff0000, v207
v_pk_fma_f32 v[40:41], v[40:41], v[28:29], v[28:29] op_sel:[0,0,1] op_sel_hi:[1,0,1]
v_pk_fma_f32 v[42:43], v[42:43], v[28:29], v[28:29] op_sel:[0,0,1] op_sel_hi:[1,0,1]
v_pk_fma_f32 v[44:45], v[44:45], v[28:29], v[28:29] op_sel:[0,0,1] op_sel_hi:[1,0,1]
v_pk_fma_f32 v[46:47], v[46:47], v[28:29], v[28:29] op_sel:[0,0,1] op_sel_hi:[1,0,1]
v_cvt_pk_bf16_f32 v204, v40, v41
v_cvt_pk_bf16_f32 v205, v42, v43
v_cvt_pk_bf16_f32 v206, v44, v45
v_cvt_pk_bf16_f32 v207, v46, v47
v_pk_fma_f32 v[32:33], v[40:41], v[48:49], v[32:33]
v_pk_fma_f32 v[34:35], v[42:43], v[48:49], v[34:35]
v_pk_fma_f32 v[36:37], v[44:45], v[48:49], v[36:37]
v_pk_fma_f32 v[38:39], v[46:47], v[48:49], v[38:39]
v_cvt_pk_bf16_f32 v56, v32, v33
v_cvt_pk_bf16_f32 v57, v34, v35
v_cvt_pk_bf16_f32 v58, v36, v37
v_cvt_pk_bf16_f32 v59, v38, v39
ds_write_b128 v15, v[56:59] offset:3072
s_add_u32 s53, s51, 5
s_and_b32 s53, s53, 7
s_mul_i32 s53, s53, 176128
s_add_u32 m0, s75, 136192
s_add_u32 s53, s53, s70
buffer_load_dwordx4 v21, s[40:43], s53 offen lds
v_lshlrev_b32 v32, 16, v80
v_and_b32 v33, 0xffff0000, v80
v_lshlrev_b32_e64 v34, 16, v81
v_and_b32 v35, 0xffff0000, v81
v_lshlrev_b32_e64 v36, 16, v82
v_and_b32 v37, 0xffff0000, v82
v_lshlrev_b32_e64 v38, 16, v83
v_and_b32 v39, 0xffff0000, v83
v_pk_fma_f32 v[32:33], v[32:33], v[22:23], v[22:23] op_sel:[0,0,1] op_sel_hi:[1,0,1]
v_pk_fma_f32 v[34:35], v[34:35], v[22:23], v[22:23] op_sel:[0,0,1] op_sel_hi:[1,0,1]
v_pk_fma_f32 v[36:37], v[36:37], v[22:23], v[22:23] op_sel:[0,0,1] op_sel_hi:[1,0,1]
v_pk_fma_f32 v[38:39], v[38:39], v[22:23], v[22:23] op_sel:[0,0,1] op_sel_hi:[1,0,1]
v_cvt_pk_bf16_f32 v80, v32, v33
v_cvt_pk_bf16_f32 v81, v34, v35
v_cvt_pk_bf16_f32 v82, v36, v37
v_cvt_pk_bf16_f32 v83, v38, v39
v_lshlrev_b32_e64 v40, 16, v208
v_and_b32 v41, 0xffff0000, v208
v_lshlrev_b32_e64 v42, 16, v209
v_and_b32 v43, 0xffff0000, v209
v_lshlrev_b32_e64 v44, 16, v210
v_and_b32 v45, 0xffff0000, v210
v_lshlrev_b32_e64 v46, 16, v211
v_and_b32 v47, 0xffff0000, v211
v_pk_fma_f32 v[40:41], v[40:41], v[22:23], v[22:23] op_sel:[0,0,1] op_sel_hi:[1,0,1]
v_pk_fma_f32 v[42:43], v[42:43], v[22:23], v[22:23] op_sel:[0,0,1] op_sel_hi:[1,0,1]
v_pk_fma_f32 v[44:45], v[44:45], v[22:23], v[22:23] op_sel:[0,0,1] op_sel_hi:[1,0,1]
v_pk_fma_f32 v[46:47], v[46:47], v[22:23], v[22:23] op_sel:[0,0,1] op_sel_hi:[1,0,1]
v_cvt_pk_bf16_f32 v208, v40, v41
v_cvt_pk_bf16_f32 v209, v42, v43
v_cvt_pk_bf16_f32 v210, v44, v45
v_cvt_pk_bf16_f32 v211, v46, v47
v_pk_fma_f32 v[32:33], v[40:41], v[48:49], v[32:33]
v_pk_fma_f32 v[34:35], v[42:43], v[48:49], v[34:35]
v_pk_fma_f32 v[36:37], v[44:45], v[48:49], v[36:37]
v_pk_fma_f32 v[38:39], v[46:47], v[48:49], v[38:39]
v_cvt_pk_bf16_f32 v52, v32, v33
v_cvt_pk_bf16_f32 v53, v34, v35
v_cvt_pk_bf16_f32 v54, v36, v37
v_cvt_pk_bf16_f32 v55, v38, v39
ds_write_b128 v14, v[52:55] offset:16384
s_add_u32 s53, s51, 2
s_and_b32 s53, s53, 7
s_mul_i32 s53, s53, 176128
s_add_u32 m0, s75, 133120
s_add_u32 s53, s53, s70
buffer_load_dwordx4 v21, s[40:43], s53 offen lds
v_lshlrev_b32 v32, 16, v84
v_and_b32 v33, 0xffff0000, v84
v_lshlrev_b32_e64 v34, 16, v85
v_and_b32 v35, 0xffff0000, v85
v_lshlrev_b32_e64 v36, 16, v86
v_and_b32 v37, 0xffff0000, v86
v_lshlrev_b32_e64 v38, 16, v87
v_and_b32 v39, 0xffff0000, v87
v_pk_fma_f32 v[32:33], v[32:33], v[24:25], v[24:25] op_sel:[0,0,1] op_sel_hi:[1,0,1]
v_pk_fma_f32 v[34:35], v[34:35], v[24:25], v[24:25] op_sel:[0,0,1] op_sel_hi:[1,0,1]
v_pk_fma_f32 v[36:37], v[36:37], v[24:25], v[24:25] op_sel:[0,0,1] op_sel_hi:[1,0,1]
v_pk_fma_f32 v[38:39], v[38:39], v[24:25], v[24:25] op_sel:[0,0,1] op_sel_hi:[1,0,1]
v_cvt_pk_bf16_f32 v84, v32, v33
v_cvt_pk_bf16_f32 v85, v34, v35
v_cvt_pk_bf16_f32 v86, v36, v37
v_cvt_pk_bf16_f32 v87, v38, v39
v_lshlrev_b32_e64 v40, 16, v212
v_and_b32 v41, 0xffff0000, v212
v_lshlrev_b32_e64 v42, 16, v213
v_and_b32 v43, 0xffff0000, v213
v_lshlrev_b32_e64 v44, 16, v214
v_and_b32 v45, 0xffff0000, v214
v_lshlrev_b32_e64 v46, 16, v215
v_and_b32 v47, 0xffff0000, v215
v_pk_fma_f32 v[40:41], v[40:41], v[24:25], v[24:25] op_sel:[0,0,1] op_sel_hi:[1,0,1]
v_pk_fma_f32 v[42:43], v[42:43], v[24:25], v[24:25] op_sel:[0,0,1] op_sel_hi:[1,0,1]
v_pk_fma_f32 v[44:45], v[44:45], v[24:25], v[24:25] op_sel:[0,0,1] op_sel_hi:[1,0,1]
v_pk_fma_f32 v[46:47], v[46:47], v[24:25], v[24:25] op_sel:[0,0,1] op_sel_hi:[1,0,1]
v_cvt_pk_bf16_f32 v212, v40, v41
v_cvt_pk_bf16_f32 v213, v42, v43
v_cvt_pk_bf16_f32 v214, v44, v45
v_cvt_pk_bf16_f32 v215, v46, v47
v_pk_fma_f32 v[32:33], v[40:41], v[48:49], v[32:33]
v_pk_fma_f32 v[34:35], v[42:43], v[48:49], v[34:35]
v_pk_fma_f32 v[36:37], v[44:45], v[48:49], v[36:37]
v_pk_fma_f32 v[38:39], v[46:47], v[48:49], v[38:39]
v_cvt_pk_bf16_f32 v56, v32, v33
v_cvt_pk_bf16_f32 v57, v34, v35
v_cvt_pk_bf16_f32 v58, v36, v37
v_cvt_pk_bf16_f32 v59, v38, v39
ds_write_b128 v15, v[56:59] offset:17408
s_add_u32 s53, s51, 6
s_and_b32 s53, s53, 7
s_mul_i32 s53, s53, 176128
s_add_u32 m0, s75, 137216
s_add_u32 s53, s53, s70
buffer_load_dwordx4 v21, s[40:43], s53 offen lds
v_lshlrev_b32 v32, 16, v88
v_and_b32 v33, 0xffff0000, v88
v_lshlrev_b32_e64 v34, 16, v89
v_and_b32 v35, 0xffff0000, v89
v_lshlrev_b32_e64 v36, 16, v90
v_and_b32 v37, 0xffff0000, v90
v_lshlrev_b32_e64 v38, 16, v91
v_and_b32 v39, 0xffff0000, v91
v_pk_fma_f32 v[32:33], v[32:33], v[26:27], v[26:27] op_sel:[0,0,1] op_sel_hi:[1,0,1]
v_pk_fma_f32 v[34:35], v[34:35], v[26:27], v[26:27] op_sel:[0,0,1] op_sel_hi:[1,0,1]
v_pk_fma_f32 v[36:37], v[36:37], v[26:27], v[26:27] op_sel:[0,0,1] op_sel_hi:[1,0,1]
v_pk_fma_f32 v[38:39], v[38:39], v[26:27], v[26:27] op_sel:[0,0,1] op_sel_hi:[1,0,1]
v_cvt_pk_bf16_f32 v88, v32, v33
v_cvt_pk_bf16_f32 v89, v34, v35
v_cvt_pk_bf16_f32 v90, v36, v37
v_cvt_pk_bf16_f32 v91, v38, v39
v_lshlrev_b32_e64 v40, 16, v216
v_and_b32 v41, 0xffff0000, v216
v_lshlrev_b32_e64 v42, 16, v217
v_and_b32 v43, 0xffff0000, v217
v_lshlrev_b32_e64 v44, 16, v218
v_and_b32 v45, 0xffff0000, v218
v_lshlrev_b32_e64 v46, 16, v219
v_and_b32 v47, 0xffff0000, v219
v_pk_fma_f32 v[40:41], v[40:41], v[26:27], v[26:27] op_sel:[0,0,1] op_sel_hi:[1,0,1]
v_pk_fma_f32 v[42:43], v[42:43], v[26:27], v[26:27] op_sel:[0,0,1] op_sel_hi:[1,0,1]
v_pk_fma_f32 v[44:45], v[44:45], v[26:27], v[26:27] op_sel:[0,0,1] op_sel_hi:[1,0,1]
v_pk_fma_f32 v[46:47], v[46:47], v[26:27], v[26:27] op_sel:[0,0,1] op_sel_hi:[1,0,1]
v_cvt_pk_bf16_f32 v216, v40, v41
v_cvt_pk_bf16_f32 v217, v42, v43
v_cvt_pk_bf16_f32 v218, v44, v45
v_cvt_pk_bf16_f32 v219, v46, v47
v_pk_fma_f32 v[32:33], v[40:41], v[48:49], v[32:33]
v_pk_fma_f32 v[34:35], v[42:43], v[48:49], v[34:35]
v_pk_fma_f32 v[36:37], v[44:45], v[48:49], v[36:37]
v_pk_fma_f32 v[38:39], v[46:47], v[48:49], v[38:39]
v_cvt_pk_bf16_f32 v52, v32, v33
v_cvt_pk_bf16_f32 v53, v34, v35
v_cvt_pk_bf16_f32 v54, v36, v37
v_cvt_pk_bf16_f32 v55, v38, v39
ds_write_b128 v14, v[52:55] offset:18432
s_add_u32 s53, s51, 3
s_and_b32 s53, s53, 7
s_mul_i32 s53, s53, 176128
s_add_u32 m0, s75, 134144
s_add_u32 s53, s53, s70
buffer_load_dwordx4 v21, s[40:43], s53 offen lds
v_lshlrev_b32 v32, 16, v92
v_and_b32 v33, 0xffff0000, v92
v_lshlrev_b32_e64 v34, 16, v93
v_and_b32 v35, 0xffff0000, v93
v_lshlrev_b32_e64 v36, 16, v94
v_and_b32 v37, 0xffff0000, v94
v_lshlrev_b32_e64 v38, 16, v95
v_and_b32 v39, 0xffff0000, v95
v_pk_fma_f32 v[32:33], v[32:33], v[28:29], v[28:29] op_sel:[0,0,1] op_sel_hi:[1,0,1]
v_pk_fma_f32 v[34:35], v[34:35], v[28:29], v[28:29] op_sel:[0,0,1] op_sel_hi:[1,0,1]
v_pk_fma_f32 v[36:37], v[36:37], v[28:29], v[28:29] op_sel:[0,0,1] op_sel_hi:[1,0,1]
v_pk_fma_f32 v[38:39], v[38:39], v[28:29], v[28:29] op_sel:[0,0,1] op_sel_hi:[1,0,1]
v_cvt_pk_bf16_f32 v92, v32, v33
v_cvt_pk_bf16_f32 v93, v34, v35
v_cvt_pk_bf16_f32 v94, v36, v37
v_cvt_pk_bf16_f32 v95, v38, v39
v_lshlrev_b32_e64 v40, 16, v220
v_and_b32 v41, 0xffff0000, v220
v_lshlrev_b32_e64 v42, 16, v221
v_and_b32 v43, 0xffff0000, v221
v_lshlrev_b32_e64 v44, 16, v222
v_and_b32 v45, 0xffff0000, v222
v_lshlrev_b32_e64 v46, 16, v223
v_and_b32 v47, 0xffff0000, v223
v_pk_fma_f32 v[40:41], v[40:41], v[28:29], v[28:29] op_sel:[0,0,1] op_sel_hi:[1,0,1]
v_pk_fma_f32 v[42:43], v[42:43], v[28:29], v[28:29] op_sel:[0,0,1] op_sel_hi:[1,0,1]
v_pk_fma_f32 v[44:45], v[44:45], v[28:29], v[28:29] op_sel:[0,0,1] op_sel_hi:[1,0,1]
v_pk_fma_f32 v[46:47], v[46:47], v[28:29], v[28:29] op_sel:[0,0,1] op_sel_hi:[1,0,1]
v_cvt_pk_bf16_f32 v220, v40, v41
v_cvt_pk_bf16_f32 v221, v42, v43
v_cvt_pk_bf16_f32 v222, v44, v45
v_cvt_pk_bf16_f32 v223, v46, v47
v_pk_fma_f32 v[32:33], v[40:41], v[48:49], v[32:33]
v_pk_fma_f32 v[34:35], v[42:43], v[48:49], v[34:35]
v_pk_fma_f32 v[36:37], v[44:45], v[48:49], v[36:37]
v_pk_fma_f32 v[38:39], v[46:47], v[48:49], v[38:39]
v_cvt_pk_bf16_f32 v56, v32, v33
v_cvt_pk_bf16_f32 v57, v34, v35
v_cvt_pk_bf16_f32 v58, v36, v37
v_cvt_pk_bf16_f32 v59, v38, v39
ds_write_b128 v15, v[56:59] offset:19456
s_add_u32 s53, s51, 7
s_and_b32 s53, s53, 7
s_mul_i32 s53, s53, 176128
s_add_u32 m0, s75, 138240
s_add_u32 s53, s53, s70
buffer_load_dwordx4 v21, s[40:43], s53 offen lds
s_waitcnt lgkmcnt(0)
s_barrier
s_and_b32 s60, s2, 7
s_lshl_b32 s60, s60, 2
s_lshr_b32 s9, s2, 6
s_add_u32 s60, s60, s9
s_lshl_b32 s62, s60, 1
s_add_u32 s62, s62, s61
s_and_b32 s62, s62, 7
s_mul_i32 s62, s62, 11
s_lshr_b32 s62, s62, 2
s_mul_i32 s71, s48, 360448
s_lshl_b32 s53, s61, 7
s_add_u32 s71, s71, s53
s_add_u32 s64, s71, 360448
s_lshl_b32 s47, s62, 14
s_add_u32 s47, s47, s71
v_lshlrev_b32_e64 v32, 16, v160
v_and_b32 v33, 0xffff0000, v160
v_lshlrev_b32_e64 v34, 16, v161
v_and_b32 v35, 0xffff0000, v161
v_lshlrev_b32_e64 v36, 16, v162
v_and_b32 v37, 0xffff0000, v162
v_lshlrev_b32_e64 v38, 16, v163
v_and_b32 v39, 0xffff0000, v163
v_fma_f32 v32, v32, v22, v23
v_fma_f32 v33, v33, v22, v23
v_fma_f32 v34, v34, v22, v23
v_fma_f32 v35, v35, v22, v23
v_fma_f32 v36, v36, v22, v23
v_fma_f32 v37, v37, v22, v23
v_fma_f32 v38, v38, v22, v23
v_fma_f32 v39, v39, v22, v23
v_cvt_pk_bf16_f32 v160, v32, v33
v_cvt_pk_bf16_f32 v161, v34, v35
v_cvt_pk_bf16_f32 v162, v36, v37
v_cvt_pk_bf16_f32 v163, v38, v39
v_lshlrev_b32_e64 v40, 16, v224
v_and_b32 v41, 0xffff0000, v224
v_lshlrev_b32_e64 v42, 16, v225
v_and_b32 v43, 0xffff0000, v225
v_lshlrev_b32_e64 v44, 16, v226
v_and_b32 v45, 0xffff0000, v226
v_lshlrev_b32_e64 v46, 16, v227
v_and_b32 v47, 0xffff0000, v227
v_fma_f32 v40, v40, v22, v23
v_fma_f32 v41, v41, v22, v23
v_fma_f32 v42, v42, v22, v23
v_fma_f32 v43, v43, v22, v23
v_fma_f32 v44, v44, v22, v23
v_fma_f32 v45, v45, v22, v23
v_fma_f32 v46, v46, v22, v23
v_fma_f32 v47, v47, v22, v23
v_cvt_pk_bf16_f32 v224, v40, v41
v_cvt_pk_bf16_f32 v225, v42, v43
v_cvt_pk_bf16_f32 v226, v44, v45
v_cvt_pk_bf16_f32 v227, v46, v47
v_fmac_f32 v32, v40, v48
v_fmac_f32 v33, v41, v48
v_fmac_f32 v34, v42, v48
v_fmac_f32 v35, v43, v48
v_fmac_f32 v36, v44, v48
v_fmac_f32 v37, v45, v48
v_fmac_f32 v38, v46, v48
v_fmac_f32 v39, v47, v48
v_cvt_pk_bf16_f32 v52, v32, v33
v_cvt_pk_bf16_f32 v53, v34, v35
v_cvt_pk_bf16_f32 v54, v36, v37
v_cvt_pk_bf16_f32 v55, v38, v39
ds_write_b128 v14, v[52:55] offset:32768
v_lshlrev_b32_e64 v32, 16, v164
v_and_b32 v33, 0xffff0000, v164
v_lshlrev_b32_e64 v34, 16, v165
v_and_b32 v35, 0xffff0000, v165
v_lshlrev_b32_e64 v36, 16, v166
v_and_b32 v37, 0xffff0000, v166
v_lshlrev_b32_e64 v38, 16, v167
v_and_b32 v39, 0xffff0000, v167
v_fma_f32 v32, v32, v24, v25
v_fma_f32 v33, v33, v24, v25
v_fma_f32 v34, v34, v24, v25
v_fma_f32 v35, v35, v24, v25
v_fma_f32 v36, v36, v24, v25
v_fma_f32 v37, v37, v24, v25
v_fma_f32 v38, v38, v24, v25
v_fma_f32 v39, v39, v24, v25
v_cvt_pk_bf16_f32 v164, v32, v33
v_cvt_pk_bf16_f32 v165, v34, v35
v_cvt_pk_bf16_f32 v166, v36, v37
v_cvt_pk_bf16_f32 v167, v38, v39
v_lshlrev_b32_e64 v40, 16, v228
v_and_b32 v41, 0xffff0000, v228
v_lshlrev_b32_e64 v42, 16, v229
v_and_b32 v43, 0xffff0000, v229
v_lshlrev_b32_e64 v44, 16, v230
v_and_b32 v45, 0xffff0000, v230
v_lshlrev_b32_e64 v46, 16, v231
v_and_b32 v47, 0xffff0000, v231
v_fma_f32 v40, v40, v24, v25
v_fma_f32 v41, v41, v24, v25
v_fma_f32 v42, v42, v24, v25
v_fma_f32 v43, v43, v24, v25
v_fma_f32 v44, v44, v24, v25
v_fma_f32 v45, v45, v24, v25
v_fma_f32 v46, v46, v24, v25
v_fma_f32 v47, v47, v24, v25
v_cvt_pk_bf16_f32 v228, v40, v41
v_cvt_pk_bf16_f32 v229, v42, v43
v_cvt_pk_bf16_f32 v230, v44, v45
v_cvt_pk_bf16_f32 v231, v46, v47
v_fmac_f32 v32, v40, v48
v_fmac_f32 v33, v41, v48
v_fmac_f32 v34, v42, v48
v_fmac_f32 v35, v43, v48
v_fmac_f32 v36, v44, v48
v_fmac_f32 v37, v45, v48
v_fmac_f32 v38, v46, v48
v_fmac_f32 v39, v47, v48
v_cvt_pk_bf16_f32 v56, v32, v33
v_cvt_pk_bf16_f32 v57, v34, v35
v_cvt_pk_bf16_f32 v58, v36, v37
v_cvt_pk_bf16_f32 v59, v38, v39
ds_write_b128 v15, v[56:59] offset:33792
v_lshlrev_b32_e64 v32, 16, v168
v_and_b32 v33, 0xffff0000, v168
v_lshlrev_b32_e64 v34, 16, v169
v_and_b32 v35, 0xffff0000, v169
v_lshlrev_b32_e64 v36, 16, v170
v_and_b32 v37, 0xffff0000, v170
v_lshlrev_b32_e64 v38, 16, v171
v_and_b32 v39, 0xffff0000, v171
v_fma_f32 v32, v32, v26, v27
v_fma_f32 v33, v33, v26, v27
v_fma_f32 v34, v34, v26, v27
v_fma_f32 v35, v35, v26, v27
v_fma_f32 v36, v36, v26, v27
v_fma_f32 v37, v37, v26, v27
v_fma_f32 v38, v38, v26, v27
v_fma_f32 v39, v39, v26, v27
v_cvt_pk_bf16_f32 v168, v32, v33
v_cvt_pk_bf16_f32 v169, v34, v35
v_cvt_pk_bf16_f32 v170, v36, v37
v_cvt_pk_bf16_f32 v171, v38, v39
v_lshlrev_b32_e64 v40, 16, v232
v_and_b32 v41, 0xffff0000, v232
v_lshlrev_b32_e64 v42, 16, v233
v_and_b32 v43, 0xffff0000, v233
v_lshlrev_b32_e64 v44, 16, v234
v_and_b32 v45, 0xffff0000, v234
v_lshlrev_b32_e64 v46, 16, v235
v_and_b32 v47, 0xffff0000, v235
v_fma_f32 v40, v40, v26, v27
v_fma_f32 v41, v41, v26, v27
v_fma_f32 v42, v42, v26, v27
v_fma_f32 v43, v43, v26, v27
v_fma_f32 v44, v44, v26, v27
v_fma_f32 v45, v45, v26, v27
v_fma_f32 v46, v46, v26, v27
v_fma_f32 v47, v47, v26, v27
v_cvt_pk_bf16_f32 v232, v40, v41
v_cvt_pk_bf16_f32 v233, v42, v43
v_cvt_pk_bf16_f32 v234, v44, v45
v_cvt_pk_bf16_f32 v235, v46, v47
v_fmac_f32 v32, v40, v48
v_fmac_f32 v33, v41, v48
v_fmac_f32 v34, v42, v48
v_fmac_f32 v35, v43, v48
v_fmac_f32 v36, v44, v48
v_fmac_f32 v37, v45, v48
v_fmac_f32 v38, v46, v48
v_fmac_f32 v39, v47, v48
v_cvt_pk_bf16_f32 v52, v32, v33
v_cvt_pk_bf16_f32 v53, v34, v35
v_cvt_pk_bf16_f32 v54, v36, v37
v_cvt_pk_bf16_f32 v55, v38, v39
ds_write_b128 v14, v[52:55] offset:34816
v_lshlrev_b32_e64 v32, 16, v172
v_and_b32 v33, 0xffff0000, v172
v_lshlrev_b32_e64 v34, 16, v173
v_and_b32 v35, 0xffff0000, v173
v_lshlrev_b32_e64 v36, 16, v174
v_and_b32 v37, 0xffff0000, v174
v_lshlrev_b32_e64 v38, 16, v175
v_and_b32 v39, 0xffff0000, v175
v_fma_f32 v32, v32, v28, v29
v_fma_f32 v33, v33, v28, v29
v_fma_f32 v34, v34, v28, v29
v_fma_f32 v35, v35, v28, v29
v_fma_f32 v36, v36, v28, v29
v_fma_f32 v37, v37, v28, v29
v_fma_f32 v38, v38, v28, v29
v_fma_f32 v39, v39, v28, v29
v_cvt_pk_bf16_f32 v172, v32, v33
v_cvt_pk_bf16_f32 v173, v34, v35
v_cvt_pk_bf16_f32 v174, v36, v37
v_cvt_pk_bf16_f32 v175, v38, v39
v_lshlrev_b32_e64 v40, 16, v236
v_and_b32 v41, 0xffff0000, v236
v_lshlrev_b32_e64 v42, 16, v237
v_and_b32 v43, 0xffff0000, v237
v_lshlrev_b32_e64 v44, 16, v238
v_and_b32 v45, 0xffff0000, v238
v_lshlrev_b32_e64 v46, 16, v239
v_and_b32 v47, 0xffff0000, v239
v_fma_f32 v40, v40, v28, v29
v_fma_f32 v41, v41, v28, v29
v_fma_f32 v42, v42, v28, v29
v_fma_f32 v43, v43, v28, v29
v_fma_f32 v44, v44, v28, v29
v_fma_f32 v45, v45, v28, v29
v_fma_f32 v46, v46, v28, v29
v_fma_f32 v47, v47, v28, v29
v_cvt_pk_bf16_f32 v236, v40, v41
v_cvt_pk_bf16_f32 v237, v42, v43
v_cvt_pk_bf16_f32 v238, v44, v45
v_cvt_pk_bf16_f32 v239, v46, v47
v_fmac_f32 v32, v40, v48
v_fmac_f32 v33, v41, v48
v_fmac_f32 v34, v42, v48
v_fmac_f32 v35, v43, v48
v_fmac_f32 v36, v44, v48
v_fmac_f32 v37, v45, v48
v_fmac_f32 v38, v46, v48
v_fmac_f32 v39, v47, v48
v_cvt_pk_bf16_f32 v56, v32, v33
v_cvt_pk_bf16_f32 v57, v34, v35
v_cvt_pk_bf16_f32 v58, v36, v37
v_cvt_pk_bf16_f32 v59, v38, v39
ds_write_b128 v15, v[56:59] offset:35840
s_waitcnt lgkmcnt(0)
s_barrier
v_min_u32 v5, 42, v0
v_lshlrev_b32 v5, 7, v5
s_lshr_b32 s54, s2, 3
s_lshl_b32 s54, s54, 2
s_add_u32 s54, s54, s48
s_mul_i32 s54, s54, 11008
s_add_u32 s54, s54, 0
buffer_load_dword v31, v5, s[24:27], s54 offen
v_min_u32 v5, 42, v0
v_lshlrev_b32 v5, 7, v5
s_lshr_b32 s54, s2, 3
s_lshl_b32 s54, s54, 2
s_add_u32 s54, s54, s48
s_mul_i32 s54, s54, 11008
s_add_u32 s54, s54, 5504
buffer_load_dword v31, v5, s[24:27], s54 offen
v_lshlrev_b32 v32, 16, v176
v_and_b32 v33, 0xffff0000, v176
v_lshlrev_b32_e64 v34, 16, v177
v_and_b32 v35, 0xffff0000, v177
v_lshlrev_b32_e64 v36, 16, v178
v_and_b32 v37, 0xffff0000, v178
v_lshlrev_b32_e64 v38, 16, v179
v_and_b32 v39, 0xffff0000, v179
v_fma_f32 v32, v32, v22, v23
v_fma_f32 v33, v33, v22, v23
v_fma_f32 v34, v34, v22, v23
v_fma_f32 v35, v35, v22, v23
v_fma_f32 v36, v36, v22, v23
v_fma_f32 v37, v37, v22, v23
v_fma_f32 v38, v38, v22, v23
v_fma_f32 v39, v39, v22, v23
v_cvt_pk_bf16_f32 v176, v32, v33
v_cvt_pk_bf16_f32 v177, v34, v35
v_cvt_pk_bf16_f32 v178, v36, v37
v_cvt_pk_bf16_f32 v179, v38, v39
v_lshlrev_b32_e64 v40, 16, v240
v_and_b32 v41, 0xffff0000, v240
v_lshlrev_b32_e64 v42, 16, v241
v_and_b32 v43, 0xffff0000, v241
v_lshlrev_b32_e64 v44, 16, v242
v_and_b32 v45, 0xffff0000, v242
v_lshlrev_b32_e64 v46, 16, v243
v_and_b32 v47, 0xffff0000, v243
v_fma_f32 v40, v40, v22, v23
v_fma_f32 v41, v41, v22, v23
v_fma_f32 v42, v42, v22, v23
v_fma_f32 v43, v43, v22, v23
v_fma_f32 v44, v44, v22, v23
v_fma_f32 v45, v45, v22, v23
v_fma_f32 v46, v46, v22, v23
v_fma_f32 v47, v47, v22, v23
v_cvt_pk_bf16_f32 v240, v40, v41
v_cvt_pk_bf16_f32 v241, v42, v43
v_cvt_pk_bf16_f32 v242, v44, v45
v_cvt_pk_bf16_f32 v243, v46, v47
v_fmac_f32 v32, v40, v48
v_fmac_f32 v33, v41, v48
v_fmac_f32 v34, v42, v48
v_fmac_f32 v35, v43, v48
v_fmac_f32 v36, v44, v48
v_fmac_f32 v37, v45, v48
v_fmac_f32 v38, v46, v48
v_fmac_f32 v39, v47, v48
v_cvt_pk_bf16_f32 v52, v32, v33
v_cvt_pk_bf16_f32 v53, v34, v35
v_cvt_pk_bf16_f32 v54, v36, v37
v_cvt_pk_bf16_f32 v55, v38, v39
ds_write_b128 v14, v[52:55] offset:0
v_lshlrev_b32_e64 v32, 16, v180
v_and_b32 v33, 0xffff0000, v180
v_lshlrev_b32_e64 v34, 16, v181
v_and_b32 v35, 0xffff0000, v181
v_lshlrev_b32_e64 v36, 16, v182
v_and_b32 v37, 0xffff0000, v182
v_lshlrev_b32_e64 v38, 16, v183
v_and_b32 v39, 0xffff0000, v183
v_fma_f32 v32, v32, v24, v25
v_fma_f32 v33, v33, v24, v25
v_fma_f32 v34, v34, v24, v25
v_fma_f32 v35, v35, v24, v25
v_fma_f32 v36, v36, v24, v25
v_fma_f32 v37, v37, v24, v25
v_fma_f32 v38, v38, v24, v25
v_fma_f32 v39, v39, v24, v25
v_cvt_pk_bf16_f32 v180, v32, v33
v_cvt_pk_bf16_f32 v181, v34, v35
v_cvt_pk_bf16_f32 v182, v36, v37
v_cvt_pk_bf16_f32 v183, v38, v39
v_lshlrev_b32_e64 v40, 16, v244
v_and_b32 v41, 0xffff0000, v244
v_lshlrev_b32_e64 v42, 16, v245
v_and_b32 v43, 0xffff0000, v245
v_lshlrev_b32_e64 v44, 16, v246
v_and_b32 v45, 0xffff0000, v246
v_lshlrev_b32_e64 v46, 16, v247
v_and_b32 v47, 0xffff0000, v247
v_fma_f32 v40, v40, v24, v25
v_fma_f32 v41, v41, v24, v25
v_fma_f32 v42, v42, v24, v25
v_fma_f32 v43, v43, v24, v25
v_fma_f32 v44, v44, v24, v25
v_fma_f32 v45, v45, v24, v25
v_fma_f32 v46, v46, v24, v25
v_fma_f32 v47, v47, v24, v25
v_cvt_pk_bf16_f32 v244, v40, v41
v_cvt_pk_bf16_f32 v245, v42, v43
v_cvt_pk_bf16_f32 v246, v44, v45
v_cvt_pk_bf16_f32 v247, v46, v47
v_fmac_f32 v32, v40, v48
v_fmac_f32 v33, v41, v48
v_fmac_f32 v34, v42, v48
v_fmac_f32 v35, v43, v48
v_fmac_f32 v36, v44, v48
v_fmac_f32 v37, v45, v48
v_fmac_f32 v38, v46, v48
v_fmac_f32 v39, v47, v48
v_cvt_pk_bf16_f32 v56, v32, v33
v_cvt_pk_bf16_f32 v57, v34, v35
v_cvt_pk_bf16_f32 v58, v36, v37
v_cvt_pk_bf16_f32 v59, v38, v39
ds_write_b128 v15, v[56:59] offset:1024
v_lshlrev_b32_e64 v32, 16, v184
v_and_b32 v33, 0xffff0000, v184
v_lshlrev_b32_e64 v34, 16, v185
v_and_b32 v35, 0xffff0000, v185
v_lshlrev_b32_e64 v36, 16, v186
v_and_b32 v37, 0xffff0000, v186
v_lshlrev_b32_e64 v38, 16, v187
v_and_b32 v39, 0xffff0000, v187
v_fma_f32 v32, v32, v26, v27
v_fma_f32 v33, v33, v26, v27
v_fma_f32 v34, v34, v26, v27
v_fma_f32 v35, v35, v26, v27
v_fma_f32 v36, v36, v26, v27
v_fma_f32 v37, v37, v26, v27
v_fma_f32 v38, v38, v26, v27
v_fma_f32 v39, v39, v26, v27
v_cvt_pk_bf16_f32 v184, v32, v33
v_cvt_pk_bf16_f32 v185, v34, v35
v_cvt_pk_bf16_f32 v186, v36, v37
v_cvt_pk_bf16_f32 v187, v38, v39
v_lshlrev_b32_e64 v40, 16, v248
v_and_b32 v41, 0xffff0000, v248
v_lshlrev_b32_e64 v42, 16, v249
v_and_b32 v43, 0xffff0000, v249
v_lshlrev_b32_e64 v44, 16, v250
v_and_b32 v45, 0xffff0000, v250
v_lshlrev_b32_e64 v46, 16, v251
v_and_b32 v47, 0xffff0000, v251
v_fma_f32 v40, v40, v26, v27
v_fma_f32 v41, v41, v26, v27
v_fma_f32 v42, v42, v26, v27
v_fma_f32 v43, v43, v26, v27
v_fma_f32 v44, v44, v26, v27
v_fma_f32 v45, v45, v26, v27
v_fma_f32 v46, v46, v26, v27
v_fma_f32 v47, v47, v26, v27
v_cvt_pk_bf16_f32 v248, v40, v41
v_cvt_pk_bf16_f32 v249, v42, v43
v_cvt_pk_bf16_f32 v250, v44, v45
v_cvt_pk_bf16_f32 v251, v46, v47
v_fmac_f32 v32, v40, v48
v_fmac_f32 v33, v41, v48
v_fmac_f32 v34, v42, v48
v_fmac_f32 v35, v43, v48
v_fmac_f32 v36, v44, v48
v_fmac_f32 v37, v45, v48
v_fmac_f32 v38, v46, v48
v_fmac_f32 v39, v47, v48
v_cvt_pk_bf16_f32 v52, v32, v33
v_cvt_pk_bf16_f32 v53, v34, v35
v_cvt_pk_bf16_f32 v54, v36, v37
v_cvt_pk_bf16_f32 v55, v38, v39
ds_write_b128 v14, v[52:55] offset:2048
v_lshlrev_b32_e64 v32, 16, v188
v_and_b32 v33, 0xffff0000, v188
v_lshlrev_b32_e64 v34, 16, v189
v_and_b32 v35, 0xffff0000, v189
v_lshlrev_b32_e64 v36, 16, v190
v_and_b32 v37, 0xffff0000, v190
v_lshlrev_b32_e64 v38, 16, v191
v_and_b32 v39, 0xffff0000, v191
v_fma_f32 v32, v32, v28, v29
v_fma_f32 v33, v33, v28, v29
v_fma_f32 v34, v34, v28, v29
v_fma_f32 v35, v35, v28, v29
v_fma_f32 v36, v36, v28, v29
v_fma_f32 v37, v37, v28, v29
v_fma_f32 v38, v38, v28, v29
v_fma_f32 v39, v39, v28, v29
v_cvt_pk_bf16_f32 v188, v32, v33
v_cvt_pk_bf16_f32 v189, v34, v35
v_cvt_pk_bf16_f32 v190, v36, v37
v_cvt_pk_bf16_f32 v191, v38, v39
v_lshlrev_b32_e64 v40, 16, v252
v_and_b32 v41, 0xffff0000, v252
v_lshlrev_b32_e64 v42, 16, v253
v_and_b32 v43, 0xffff0000, v253
v_lshlrev_b32_e64 v44, 16, v254
v_and_b32 v45, 0xffff0000, v254
v_lshlrev_b32_e64 v46, 16, v255
v_and_b32 v47, 0xffff0000, v255
v_fma_f32 v40, v40, v28, v29
v_fma_f32 v41, v41, v28, v29
v_fma_f32 v42, v42, v28, v29
v_fma_f32 v43, v43, v28, v29
v_fma_f32 v44, v44, v28, v29
v_fma_f32 v45, v45, v28, v29
v_fma_f32 v46, v46, v28, v29
v_fma_f32 v47, v47, v28, v29
v_cvt_pk_bf16_f32 v252, v40, v41
v_cvt_pk_bf16_f32 v253, v42, v43
v_cvt_pk_bf16_f32 v254, v44, v45
v_cvt_pk_bf16_f32 v255, v46, v47
v_fmac_f32 v32, v40, v48
v_fmac_f32 v33, v41, v48
v_fmac_f32 v34, v42, v48
v_fmac_f32 v35, v43, v48
v_fmac_f32 v36, v44, v48
v_fmac_f32 v37, v45, v48
v_fmac_f32 v38, v46, v48
v_fmac_f32 v39, v47, v48
v_cvt_pk_bf16_f32 v56, v32, v33
v_cvt_pk_bf16_f32 v57, v34, v35
v_cvt_pk_bf16_f32 v58, v36, v37
v_cvt_pk_bf16_f32 v59, v38, v39
ds_write_b128 v15, v[56:59] offset:3072
s_waitcnt vmcnt(2)
s_waitcnt lgkmcnt(0)
s_barrier
s_setprio 0
v_and_b32 v12, 31, v0
v_lshrrev_b32 v7, 5, v0
v_bfe_u32 v13, v0, 1, 3
v_xor_b32 v13, v13, v7
v_lshlrev_b32 v12, 7, v12
v_xor_b32_e64 v14, 0, v13
v_lshl_add_u32 v8, v14, 4, v12
v_xor_b32_e64 v14, 2, v13
v_lshl_add_u32 v9, v14, 4, v12
v_xor_b32_e64 v14, 4, v13
v_lshl_add_u32 v10, v14, 4, v12
v_xor_b32_e64 v14, 6, v13
v_lshl_add_u32 v11, v14, 4, v12
v_lshl_add_u32 v12, v6, 7, v2
v_lshl_add_u32 v13, v6, 7, v3
s_add_u32 s53, s63, 114688
v_add_u32 v12, s53, v12
v_add_u32 v13, s53, v13
v_add_u32 v8, s53, v8
v_add_u32 v9, s53, v9
v_add_u32 v10, s53, v10
v_add_u32 v11, s53, v11
v_lshrrev_b32_e64 v5, 5, v0
v_bfe_u32 v7, v0, 2, 2
v_lshl_add_u32 v5, v5, 3, v7
v_lshlrev_b32 v5, 5, v5
v_and_b32 v7, 3, v0
v_lshl_add_u32 v5, v7, 3, v5
v_bfe_u32 v7, v0, 4, 1
v_lshl_add_u32 v5, v7, 13, v5
v_add_u32 v19, 131072, v5
ds_write_b128 v12, v[64:67] offset:0
ds_write_b128 v13, v[68:71] offset:1024
ds_write_b128 v12, v[72:75] offset:2048
ds_write_b128 v13, v[76:79] offset:3072
ds_read_b128 v[144:147], v8
ds_read_b64_tr_b16 v[96:97], v19 offset:0
ds_read_b64_tr_b16 v[98:99], v19 offset:128
ds_read_b128 v[148:151], v9
ds_read_b64_tr_b16 v[100:101], v19 offset:512
ds_read_b64_tr_b16 v[102:103], v19 offset:640
ds_read_b128 v[152:155], v10
ds_read_b64_tr_b16 v[104:105], v19 offset:16384
ds_read_b64_tr_b16 v[106:107], v19 offset:16512
ds_read_b128 v[156:159], v11
ds_read_b64_tr_b16 v[108:109], v19 offset:16896
ds_read_b64_tr_b16 v[110:111], v19 offset:17024
s_add_u32 m0, s46, 0
s_add_u32 s53, s47, 16384
buffer_load_dwordx4 v20, s[24:27], s47 offen lds
s_add_u32 m0, s46, 960
s_add_u32 s53, s47, 16384
buffer_load_dwordx4 v20, s[24:27], s47 offen offset:64 lds
s_cmp_ge_u32 s53, s64
s_cselect_b32 s47, s71, s53
s_add_u32 m0, s46, 2048
s_add_u32 s53, s47, 16384
buffer_load_dwordx4 v20, s[24:27], s47 offen lds
s_add_u32 m0, s46, 3008
s_add_u32 s53, s47, 16384
buffer_load_dwordx4 v20, s[24:27], s47 offen offset:64 lds
s_cmp_ge_u32 s53, s64
s_cselect_b32 s47, s71, s53
s_add_u32 m0, s46, 4096
s_add_u32 s53, s47, 16384
buffer_load_dwordx4 v20, s[24:27], s47 offen lds
s_add_u32 m0, s46, 5056
s_add_u32 s53, s47, 16384
buffer_load_dwordx4 v20, s[24:27], s47 offen offset:64 lds
s_cmp_ge_u32 s53, s64
s_cselect_b32 s47, s71, s53
s_add_u32 m0, s46, 6144
s_add_u32 s53, s47, 16384
buffer_load_dwordx4 v20, s[24:27], s47 offen lds
s_add_u32 m0, s46, 7104
s_add_u32 s53, s47, 16384
buffer_load_dwordx4 v20, s[24:27], s47 offen offset:64 lds
s_cmp_ge_u32 s53, s64
s_cselect_b32 s47, s71, s53
s_add_u32 m0, s46, 8192
s_add_u32 s53, s47, 16384
buffer_load_dwordx4 v20, s[24:27], s47 offen lds
s_add_u32 m0, s46, 9152
s_add_u32 s53, s47, 16384
buffer_load_dwordx4 v20, s[24:27], s47 offen offset:64 lds
s_cmp_ge_u32 s53, s64
s_cselect_b32 s47, s71, s53
s_add_u32 m0, s46, 10240
s_add_u32 s53, s47, 16384
buffer_load_dwordx4 v20, s[24:27], s47 offen lds
s_add_u32 m0, s46, 11200
s_add_u32 s53, s47, 16384
buffer_load_dwordx4 v20, s[24:27], s47 offen offset:64 lds
s_cmp_ge_u32 s53, s64
s_cselect_b32 s47, s71, s53
s_add_u32 m0, s46, 12288
s_add_u32 s53, s47, 16384
buffer_load_dwordx4 v20, s[24:27], s47 offen lds
s_add_u32 m0, s46, 13248
s_add_u32 s53, s47, 16384
buffer_load_dwordx4 v20, s[24:27], s47 offen offset:64 lds
s_cmp_ge_u32 s53, s64
s_cselect_b32 s47, s71, s53
ds_write_b128 v12, v[192:195] offset:0
ds_write_b128 v13, v[196:199] offset:1024
ds_write_b128 v12, v[200:203] offset:2048
ds_write_b128 v13, v[204:207] offset:3072
s_waitcnt lgkmcnt(4)
v_mfma_f32_32x32x16_bf16 v[128:143], v[96:99], v[144:147], 0
ds_read_b128 v[32:35], v8
ds_read_b64_tr_b16 v[112:113], v19 offset:4096
ds_read_b64_tr_b16 v[114:115], v19 offset:4224
v_mfma_f32_32x32x16_bf16 v[128:143], v[100:103], v[148:151], v[128:143]
ds_read_b128 v[36:39], v9
ds_read_b64_tr_b16 v[116:117], v19 offset:4608
ds_read_b64_tr_b16 v[118:119], v19 offset:4736
v_mfma_f32_32x32x16_bf16 v[128:143], v[104:107], v[152:155], v[128:143]
ds_read_b128 v[40:43], v10
ds_read_b64_tr_b16 v[120:121], v19 offset:20480
ds_read_b64_tr_b16 v[122:123], v19 offset:20608
v_mfma_f32_32x32x16_bf16 v[128:143], v[108:111], v[156:159], v[128:143]
ds_read_b128 v[44:47], v11
ds_read_b64_tr_b16 v[124:125], v19 offset:20992
ds_read_b64_tr_b16 v[126:127], v19 offset:21120
ds_write_b128 v12, v[80:83] offset:0
ds_write_b128 v13, v[84:87] offset:1024
ds_write_b128 v12, v[88:91] offset:2048
ds_write_b128 v13, v[92:95] offset:3072
s_waitcnt lgkmcnt(4)
v_mfma_f32_32x32x16_bf16 v[128:143], v[112:115], v[32:35], v[128:143]
ds_read_b128 v[144:147], v8
ds_read_b64_tr_b16 v[96:97], v19 offset:1024
ds_read_b64_tr_b16 v[98:99], v19 offset:1152
v_mfma_f32_32x32x16_bf16 v[128:143], v[116:119], v[36:39], v[128:143]
ds_read_b128 v[148:151], v9
ds_read_b64_tr_b16 v[100:101], v19 offset:1536
ds_read_b64_tr_b16 v[102:103], v19 offset:1664
v_mfma_f32_32x32x16_bf16 v[128:143], v[120:123], v[40:43], v[128:143]
ds_read_b128 v[152:155], v10
ds_read_b64_tr_b16 v[104:105], v19 offset:17408
ds_read_b64_tr_b16 v[106:107], v19 offset:17536
v_mfma_f32_32x32x16_bf16 v[128:143], v[124:127], v[44:47], v[128:143]
ds_read_b128 v[156:159], v11
ds_read_b64_tr_b16 v[108:109], v19 offset:17920
ds_read_b64_tr_b16 v[110:111], v19 offset:18048
ds_write_b128 v12, v[208:211] offset:0
ds_write_b128 v13, v[212:215] offset:1024
ds_write_b128 v12, v[216:219] offset:2048
ds_write_b128 v13, v[220:223] offset:3072
s_waitcnt lgkmcnt(4)
v_mfma_f32_32x32x16_bf16 v[128:143], v[96:99], v[144:147], v[128:143]
ds_read_b128 v[32:35], v8
ds_read_b64_tr_b16 v[112:113], v19 offset:5120
ds_read_b64_tr_b16 v[114:115], v19 offset:5248
v_mfma_f32_32x32x16_bf16 v[128:143], v[100:103], v[148:151], v[128:143]
ds_read_b128 v[36:39], v9
ds_read_b64_tr_b16 v[116:117], v19 offset:5632
ds_read_b64_tr_b16 v[118:119], v19 offset:5760
v_mfma_f32_32x32x16_bf16 v[128:143], v[104:107], v[152:155], v[128:143]
ds_read_b128 v[40:43], v10
ds_read_b64_tr_b16 v[120:121], v19 offset:21504
ds_read_b64_tr_b16 v[122:123], v19 offset:21632
v_mfma_f32_32x32x16_bf16 v[128:143], v[108:111], v[156:159], v[128:143]
ds_read_b128 v[44:47], v11
ds_read_b64_tr_b16 v[124:125], v19 offset:22016
ds_read_b64_tr_b16 v[126:127], v19 offset:22144
ds_write_b128 v12, v[160:163] offset:0
ds_write_b128 v13, v[164:167] offset:1024
ds_write_b128 v12, v[168:171] offset:2048
ds_write_b128 v13, v[172:175] offset:3072
s_waitcnt lgkmcnt(4)
v_mfma_f32_32x32x16_bf16 v[128:143], v[112:115], v[32:35], v[128:143]
ds_read_b128 v[144:147], v8
ds_read_b64_tr_b16 v[96:97], v19 offset:2048
ds_read_b64_tr_b16 v[98:99], v19 offset:2176
v_mfma_f32_32x32x16_bf16 v[128:143], v[116:119], v[36:39], v[128:143]
ds_read_b128 v[148:151], v9
ds_read_b64_tr_b16 v[100:101], v19 offset:2560
ds_read_b64_tr_b16 v[102:103], v19 offset:2688
v_mfma_f32_32x32x16_bf16 v[128:143], v[120:123], v[40:43], v[128:143]
ds_read_b128 v[152:155], v10
ds_read_b64_tr_b16 v[104:105], v19 offset:18432
ds_read_b64_tr_b16 v[106:107], v19 offset:18560
v_mfma_f32_32x32x16_bf16 v[128:143], v[124:127], v[44:47], v[128:143]
ds_read_b128 v[156:159], v11
ds_read_b64_tr_b16 v[108:109], v19 offset:18944
ds_read_b64_tr_b16 v[110:111], v19 offset:19072
ds_write_b128 v12, v[224:227] offset:0
ds_write_b128 v13, v[228:231] offset:1024
ds_write_b128 v12, v[232:235] offset:2048
ds_write_b128 v13, v[236:239] offset:3072
s_waitcnt lgkmcnt(4)
v_mfma_f32_32x32x16_bf16 v[128:143], v[96:99], v[144:147], v[128:143]
ds_read_b128 v[32:35], v8
ds_read_b64_tr_b16 v[112:113], v19 offset:6144
ds_read_b64_tr_b16 v[114:115], v19 offset:6272
v_mfma_f32_32x32x16_bf16 v[128:143], v[100:103], v[148:151], v[128:143]
ds_read_b128 v[36:39], v9
ds_read_b64_tr_b16 v[116:117], v19 offset:6656
ds_read_b64_tr_b16 v[118:119], v19 offset:6784
v_mfma_f32_32x32x16_bf16 v[128:143], v[104:107], v[152:155], v[128:143]
ds_read_b128 v[40:43], v10
ds_read_b64_tr_b16 v[120:121], v19 offset:22528
ds_read_b64_tr_b16 v[122:123], v19 offset:22656
v_mfma_f32_32x32x16_bf16 v[128:143], v[108:111], v[156:159], v[128:143]
ds_read_b128 v[44:47], v11
ds_read_b64_tr_b16 v[124:125], v19 offset:23040
ds_read_b64_tr_b16 v[126:127], v19 offset:23168
ds_write_b128 v12, v[176:179] offset:0
ds_write_b128 v13, v[180:183] offset:1024
ds_write_b128 v12, v[184:187] offset:2048
ds_write_b128 v13, v[188:191] offset:3072
s_waitcnt lgkmcnt(4)
v_mfma_f32_32x32x16_bf16 v[128:143], v[112:115], v[32:35], v[128:143]
ds_read_b128 v[144:147], v8
ds_read_b64_tr_b16 v[96:97], v19 offset:3072
ds_read_b64_tr_b16 v[98:99], v19 offset:3200
v_mfma_f32_32x32x16_bf16 v[128:143], v[116:119], v[36:39], v[128:143]
ds_read_b128 v[148:151], v9
ds_read_b64_tr_b16 v[100:101], v19 offset:3584
ds_read_b64_tr_b16 v[102:103], v19 offset:3712
v_mfma_f32_32x32x16_bf16 v[128:143], v[120:123], v[40:43], v[128:143]
ds_read_b128 v[152:155], v10
ds_read_b64_tr_b16 v[104:105], v19 offset:19456
ds_read_b64_tr_b16 v[106:107], v19 offset:19584
v_mfma_f32_32x32x16_bf16 v[128:143], v[124:127], v[44:47], v[128:143]
ds_read_b128 v[156:159], v11
ds_read_b64_tr_b16 v[108:109], v19 offset:19968
ds_read_b64_tr_b16 v[110:111], v19 offset:20096
ds_write_b128 v12, v[240:243] offset:0
ds_write_b128 v13, v[244:247] offset:1024
ds_write_b128 v12, v[248:251] offset:2048
ds_write_b128 v13, v[252:255] offset:3072
s_waitcnt lgkmcnt(4)
v_mfma_f32_32x32x16_bf16 v[128:143], v[96:99], v[144:147], v[128:143]
ds_read_b128 v[32:35], v8
ds_read_b64_tr_b16 v[112:113], v19 offset:7168
ds_read_b64_tr_b16 v[114:115], v19 offset:7296
v_mfma_f32_32x32x16_bf16 v[128:143], v[100:103], v[148:151], v[128:143]
ds_read_b128 v[36:39], v9
ds_read_b64_tr_b16 v[116:117], v19 offset:7680
ds_read_b64_tr_b16 v[118:119], v19 offset:7808
v_mfma_f32_32x32x16_bf16 v[128:143], v[104:107], v[152:155], v[128:143]
ds_read_b128 v[40:43], v10
ds_read_b64_tr_b16 v[120:121], v19 offset:23552
ds_read_b64_tr_b16 v[122:123], v19 offset:23680
v_mfma_f32_32x32x16_bf16 v[128:143], v[108:111], v[156:159], v[128:143]
ds_read_b128 v[44:47], v11
ds_read_b64_tr_b16 v[124:125], v19 offset:24064
ds_read_b64_tr_b16 v[126:127], v19 offset:24192
s_waitcnt lgkmcnt(0)
v_mfma_f32_32x32x16_bf16 v[128:143], v[112:115], v[32:35], v[128:143]
v_mfma_f32_32x32x16_bf16 v[128:143], v[116:119], v[36:39], v[128:143]
v_mfma_f32_32x32x16_bf16 v[128:143], v[120:123], v[40:43], v[128:143]
v_mfma_f32_32x32x16_bf16 v[128:143], v[124:127], v[44:47], v[128:143]
v_mov_b32 v15, 14336
v_mov_b32 v4, 1
s_mov_b64 exec, 1
ds_add_u32 v15, v4 offset:12
s_mov_b64 exec, -1
v_mov_b32_e64 v30, 0
buffer_load_dword v31, v30, s[32:35], 0 offen sc1
v_lshlrev_b32_e64 v5, 4, v0
s_add_u32 s54, s59, 84
s_lshl_b32 s54, s54, 11
s_add_u32 s54, s54, s68
s_add_u32 s55, s54, 4096
v_mov_b32 v44, 0
v_mov_b32 v45, 0
v_mov_b32 v46, 0
v_mov_b32 v47, 0
s_nop 7
v_pk_mul_f32 v[32:33], v[128:129], s[76:77]
v_pk_mul_f32 v[34:35], v[130:131], s[76:77]
v_pk_mul_f32 v[36:37], v[132:133], s[76:77]
v_pk_mul_f32 v[38:39], v[134:135], s[76:77]
v_exp_f32 v32, v32
v_exp_f32 v33, v33
v_exp_f32 v34, v34
v_exp_f32 v35, v35
v_exp_f32 v36, v36
v_exp_f32 v37, v37
v_exp_f32 v38, v38
v_exp_f32_e64 v39, v39
v_pk_mul_f32 v[128:129], v[128:129], v[136:137]
v_pk_mul_f32 v[130:131], v[130:131], v[138:139]
v_pk_mul_f32 v[132:133], v[132:133], v[140:141]
v_pk_mul_f32 v[134:135], v[134:135], v[142:143]
v_pk_add_f32 v[32:33], v[32:33], 1.0 op_sel_hi:[1,0]
v_pk_add_f32 v[34:35], v[34:35], 1.0 op_sel_hi:[1,0]
v_pk_add_f32 v[36:37], v[36:37], 1.0 op_sel_hi:[1,0]
v_pk_add_f32 v[38:39], v[38:39], 1.0 op_sel_hi:[1,0]
v_rcp_f32 v32, v32
v_rcp_f32 v33, v33
v_rcp_f32 v34, v34
v_rcp_f32 v35, v35
v_rcp_f32 v36, v36
v_rcp_f32 v37, v37
v_rcp_f32 v38, v38
v_rcp_f32 v39, v39
s_nop 0
v_pk_mul_f32 v[128:129], v[128:129], v[32:33]
v_pk_mul_f32 v[130:131], v[130:131], v[34:35]
v_pk_mul_f32 v[132:133], v[132:133], v[36:37]
v_pk_mul_f32 v[134:135], v[134:135], v[38:39]
v_cvt_pk_bf16_f32 v40, v128, v129
v_cvt_pk_bf16_f32 v41, v130, v131
v_cvt_pk_bf16_f32 v42, v132, v133
v_cvt_pk_bf16_f32 v43, v134, v135
buffer_store_dwordx4 v[40:43], v5, s[36:39], s54 offen sc1
buffer_store_dwordx4 v[44:47], v5, s[36:39], s55 offen sc1
s_waitcnt vmcnt(0)
v_mov_b32 v15, 14336
v_mov_b32 v4, 1
s_mov_b64 exec, 1
ds_add_rtn_u32 v4, v15, v4 offset:16
s_mov_b64 exec, -1
s_waitcnt lgkmcnt(0)
v_readfirstlane_b32 s53, v4
s_and_b32 s53, s53, 3
s_cmp_lg_u32 s53, 3
s_cbranch_scc1 LsAskip
s_mov_b32 s56, 0
LsApoll:
v_readfirstlane_b32 s53, v31
s_cmp_lg_u32 s53, 0
s_cbranch_scc1 LsAok
s_add_u32 s56, s56, 1
s_cmp_ge_u32 s56, 0x80000
s_cbranch_scc1 LsAok
s_sleep 2
buffer_load_dword v31, v30, s[32:35], 0 offen sc1
s_waitcnt vmcnt(0)
s_branch LsApoll
LsAok:
v_lshlrev_b32 v29, 7, v0
s_mov_b64 exec, 3
buffer_store_dword v31, v29, s[36:39], s73 offen sc1
s_mov_b64 exec, -1
LsAskip:
s_mov_b32 s56, 0
LwF:
ds_read_b32 v4, v15 offset:12
s_waitcnt lgkmcnt(0)
v_readfirstlane_b32 s53, v4
s_add_u32 s56, s56, 1
s_cmp_ge_u32 s56, 0x800000
s_cbranch_scc1 LwFx
s_cmp_ge_u32 s53, 68
s_cbranch_scc1 LwFx
s_sleep 1
s_branch LwF
LwFx:
s_add_u32 s47, s47, 98304
s_sub_u32 s53, s47, 360448
s_cmp_ge_u32 s47, s64
s_cselect_b32 s47, s53, s47
v_mov_b32_e64 v30, 0
buffer_load_dword v31, v30, s[32:35], 0 offen sc1
LH2:
s_setprio 0
s_add_u32 m0, s3, 114688
s_add_u32 s53, s47, 16384
buffer_load_dwordx4 v20, s[24:27], s47 offen lds
s_add_u32 m0, s3, 115648
s_add_u32 s53, s47, 16384
buffer_load_dwordx4 v20, s[24:27], s47 offen offset:64 lds
s_cmp_ge_u32 s53, s64
s_cselect_b32 s47, s71, s53
s_add_u32 m0, s3, 116736
s_add_u32 s53, s47, 16384
buffer_load_dwordx4 v20, s[24:27], s47 offen lds
s_add_u32 m0, s3, 117696
s_add_u32 s53, s47, 16384
buffer_load_dwordx4 v20, s[24:27], s47 offen offset:64 lds
s_cmp_ge_u32 s53, s64
s_cselect_b32 s47, s71, s53
s_add_u32 m0, s3, 118784
s_add_u32 s53, s47, 16384
buffer_load_dwordx4 v20, s[24:27], s47 offen lds
s_add_u32 m0, s3, 119744
s_add_u32 s53, s47, 16384
buffer_load_dwordx4 v20, s[24:27], s47 offen offset:64 lds
s_cmp_ge_u32 s53, s64
s_cselect_b32 s47, s71, s53
s_add_u32 m0, s3, 120832
s_add_u32 s53, s47, 16384
buffer_load_dwordx4 v20, s[24:27], s47 offen lds
s_add_u32 m0, s3, 121792
s_add_u32 s53, s47, 16384
buffer_load_dwordx4 v20, s[24:27], s47 offen offset:64 lds
s_cmp_ge_u32 s53, s64
s_cselect_b32 s47, s71, s53
s_add_u32 m0, s3, 122880
s_add_u32 s53, s47, 16384
buffer_load_dwordx4 v20, s[24:27], s47 offen lds
s_add_u32 m0, s3, 123840
s_add_u32 s53, s47, 16384
buffer_load_dwordx4 v20, s[24:27], s47 offen offset:64 lds
s_cmp_ge_u32 s53, s64
s_cselect_b32 s47, s71, s53
s_add_u32 m0, s3, 124928
s_add_u32 s53, s47, 16384
buffer_load_dwordx4 v20, s[24:27], s47 offen lds
s_add_u32 m0, s3, 125888
s_add_u32 s53, s47, 16384
buffer_load_dwordx4 v20, s[24:27], s47 offen offset:64 lds
s_cmp_ge_u32 s53, s64
s_cselect_b32 s47, s71, s53
v_lshrrev_b32 v5, 5, v0
v_bfe_u32 v7, v0, 2, 2
v_lshl_add_u32 v5, v5, 2, v7
v_lshlrev_b32_e64 v5, 6, v5
v_bfe_u32 v7, v0, 4, 1
v_lshl_add_u32 v5, v7, 5, v5
v_and_b32_e64 v7, 3, v0
v_lshl_add_u32 v5, v7, 3, v5
s_add_u32 s53, s46, 0
v_add_u32 v8, s53, v5
s_add_u32 s53, s74, 65536
v_add_u32_e64 v9, s53, v5
s_add_u32 s53, s3, 114688
v_add_u32 v10, s53, v5
s_waitcnt vmcnt(37)
ds_read_b64_tr_b16 v[224:225], v8 offset:0
ds_read_b64_tr_b16 v[226:227], v8 offset:512
ds_read_b64_tr_b16 v[228:229], v8 offset:1024
ds_read_b64_tr_b16 v[230:231], v8 offset:1536
s_waitcnt vmcnt(35)
ds_read_b64_tr_b16 v[232:233], v8 offset:2048
ds_read_b64_tr_b16 v[234:235], v8 offset:2560
ds_read_b64_tr_b16 v[236:237], v8 offset:3072
ds_read_b64_tr_b16 v[238:239], v8 offset:3584
s_waitcnt vmcnt(33)
ds_read_b64_tr_b16 v[240:241], v8 offset:4096
ds_read_b64_tr_b16 v[242:243], v8 offset:4608
ds_read_b64_tr_b16 v[244:245], v8 offset:5120
ds_read_b64_tr_b16 v[246:247], v8 offset:5632
s_waitcnt lgkmcnt(0)
s_add_u32 m0, s46, 0
s_add_u32 s53, s47, 16384
buffer_load_dwordx4 v20, s[24:27], s47 offen lds
s_add_u32 m0, s46, 960
s_add_u32 s53, s47, 16384
buffer_load_dwordx4 v20, s[24:27], s47 offen offset:64 lds
s_cmp_ge_u32 s53, s64
s_cselect_b32 s47, s71, s53
s_add_u32 m0, s46, 2048
s_add_u32 s53, s47, 16384
buffer_load_dwordx4 v20, s[24:27], s47 offen lds
s_add_u32 m0, s46, 3008
s_add_u32 s53, s47, 16384
buffer_load_dwordx4 v20, s[24:27], s47 offen offset:64 lds
s_cmp_ge_u32 s53, s64
s_cselect_b32 s47, s71, s53
s_add_u32 m0, s46, 4096
s_add_u32 s53, s47, 16384
buffer_load_dwordx4 v20, s[24:27], s47 offen lds
s_add_u32 m0, s46, 5056
s_add_u32 s53, s47, 16384
buffer_load_dwordx4 v20, s[24:27], s47 offen offset:64 lds
s_cmp_ge_u32 s53, s64
s_cselect_b32 s47, s71, s53
v_mov_b32 v15, 14336
v_lshlrev_b32_e64 v2, 4, v0
s_mul_i32 s65, s60, 184320
s_mul_i32 s53, s48, 45056
s_add_u32 s65, s65, s53
s_add_u32 s64, s65, 45056
s_lshl_b32 s47, s62, 11
s_add_u32 s47, s47, s65
s_add_u32 s53, s3, 114688
v_add_u32 v13, s53, v2
v_add_u32 v14, s46, v2
s_lshl_b32 s69, s60, 7
s_add_u32 s69, s69, 8396800
v_and_b32 v5, 15, v0
v_lshlrev_b32 v5, 2, v5
s_cmp_lg_u32 s48, 0
s_cbranch_scc1 LBwA
s_cmp_ge_u32 s50, 14
s_cselect_b32 s9, 4, 0
s_mov_b32 s56, 0
LwD:
ds_read_b32 v4, v15 offset:20
s_waitcnt lgkmcnt(0)
v_readfirstlane_b32 s53, v4
s_add_u32 s56, s56, 1
s_cmp_ge_u32 s56, 0x800000
s_cbranch_scc1 LwDx
s_cmp_ge_u32 s53, s9
s_cbranch_scc1 LwDx
s_sleep 1
s_branch LwD
LwDx:
s_waitcnt vmcnt(18)
s_mov_b32 s56, 0
LiHpoll:
v_readfirstlane_b32 s53, v31
s_cmp_lg_u32 s53, 0
s_cbranch_scc1 LiHok
s_add_u32 s56, s56, 1
s_cmp_ge_u32 s56, 0x80000
s_cbranch_scc1 LiHok
s_sleep 2
buffer_load_dword v31, v30, s[32:35], 0 offen sc1
s_waitcnt vmcnt(0)
s_branch LiHpoll
LiHok:
s_mov_b32 s56, 0
LpA:
buffer_load_dword v4, v5, s[36:39], s69 offen sc1
s_waitcnt vmcnt(0)
v_cmp_eq_u32 vcc, 0, v4
s_add_u32 s56, s56, 1
s_cmp_ge_u32 s56, 0x80000
s_cbranch_scc1 LpAdone
s_cbranch_vccz LpAdone
s_sleep 4
s_branch LpA
LpAdone:
v_mov_b32 v4, 1
ds_write_b32 v15, v4
s_branch LwAx
LBwA:
s_waitcnt vmcnt(0)
s_mov_b32 s56, 0
LwA:
ds_read_b32 v4, v15 offset:0
s_waitcnt lgkmcnt(0)
v_readfirstlane_b32 s53, v4
s_add_u32 s56, s56, 1
s_cmp_ge_u32 s56, 0x800000
s_cbranch_scc1 LwAx
s_cmp_ge_u32 s53, 1
s_cbranch_scc1 LwAx
s_sleep 1
s_branch LwA
LwAx:
buffer_load_dwordx4 v[128:131], v2, s[36:39], s47 offen sc1
s_add_u32 s53, s47, 2048
buffer_load_dwordx4 v[132:135], v2, s[36:39], s47 offen offset:1024 sc1
s_cmp_ge_u32 s53, s64
s_cselect_b32 s47, s65, s53
buffer_load_dwordx4 v[136:139], v2, s[36:39], s47 offen sc1
s_add_u32 s53, s47, 2048
buffer_load_dwordx4 v[140:143], v2, s[36:39], s47 offen offset:1024 sc1
s_cmp_ge_u32 s53, s64
s_cselect_b32 s47, s65, s53
buffer_load_dwordx4 v[144:147], v2, s[36:39], s47 offen sc1
s_add_u32 s53, s47, 2048
buffer_load_dwordx4 v[148:151], v2, s[36:39], s47 offen offset:1024 sc1
s_cmp_ge_u32 s53, s64
s_cselect_b32 s47, s65, s53
buffer_load_dwordx4 v[152:155], v2, s[36:39], s47 offen sc1
s_add_u32 s53, s47, 2048
buffer_load_dwordx4 v[156:159], v2, s[36:39], s47 offen offset:1024 sc1
s_cmp_ge_u32 s53, s64
s_cselect_b32 s47, s65, s53
buffer_load_dwordx4 v[160:163], v2, s[36:39], s47 offen sc1
s_add_u32 s53, s47, 2048
buffer_load_dwordx4 v[164:167], v2, s[36:39], s47 offen offset:1024 sc1
s_cmp_ge_u32 s53, s64
s_cselect_b32 s47, s65, s53
buffer_load_dwordx4 v[168:171], v2, s[36:39], s47 offen sc1
s_add_u32 s53, s47, 2048
buffer_load_dwordx4 v[172:175], v2, s[36:39], s47 offen offset:1024 sc1
s_cmp_ge_u32 s53, s64
s_cselect_b32 s47, s65, s53
buffer_load_dwordx4 v[176:179], v2, s[36:39], s47 offen sc1
s_add_u32 s53, s47, 2048
buffer_load_dwordx4 v[180:183], v2, s[36:39], s47 offen offset:1024 sc1
s_cmp_ge_u32 s53, s64
s_cselect_b32 s47, s65, s53
s_waitcnt vmcnt(12)
v_mfma_f32_32x32x16_bf16 v[64:79], v[224:227], v[128:131], 0
v_mfma_f32_32x32x16_bf16 v[80:95], v[228:231], v[128:131], 0
ds_read_b64_tr_b16 v[248:249], v8 offset:6144
ds_read_b64_tr_b16 v[250:251], v8 offset:6656
ds_read_b64_tr_b16 v[252:253], v8 offset:7168
ds_read_b64_tr_b16 v[254:255], v8 offset:7680
buffer_load_dwordx4 v[184:187], v2, s[36:39], s47 offen sc1
s_add_u32 s53, s47, 2048
buffer_load_dwordx4 v[188:191], v2, s[36:39], s47 offen offset:1024 sc1
s_cmp_ge_u32 s53, s64
s_cselect_b32 s47, s65, s53
v_mfma_f32_32x32x16_bf16 v[96:111], v[224:227], v[132:135], 0
v_mfma_f32_32x32x16_bf16 v[112:127], v[228:231], v[132:135], 0
s_waitcnt vmcnt(12)
v_mfma_f32_32x32x16_bf16 v[64:79], v[232:235], v[136:139], v[64:79]
v_mfma_f32_32x32x16_bf16 v[80:95], v[236:239], v[136:139], v[80:95]
ds_read_b64_tr_b16 v[224:225], v8 offset:8192
ds_read_b64_tr_b16 v[226:227], v8 offset:8704
ds_read_b64_tr_b16 v[228:229], v8 offset:9216
ds_read_b64_tr_b16 v[230:231], v8 offset:9728
buffer_load_dwordx4 v[192:195], v2, s[36:39], s47 offen sc1
s_add_u32 s53, s47, 2048
buffer_load_dwordx4 v[196:199], v2, s[36:39], s47 offen offset:1024 sc1
s_cmp_ge_u32 s53, s64
s_cselect_b32 s47, s65, s53
v_mfma_f32_32x32x16_bf16 v[96:111], v[232:235], v[140:143], v[96:111]
v_mfma_f32_32x32x16_bf16 v[112:127], v[236:239], v[140:143], v[112:127]
s_waitcnt vmcnt(12)
v_mfma_f32_32x32x16_bf16 v[64:79], v[240:243], v[144:147], v[64:79]
v_mfma_f32_32x32x16_bf16 v[80:95], v[244:247], v[144:147], v[80:95]
ds_read_b64_tr_b16 v[232:233], v8 offset:10240
ds_read_b64_tr_b16 v[234:235], v8 offset:10752
ds_read_b64_tr_b16 v[236:237], v8 offset:11264
ds_read_b64_tr_b16 v[238:239], v8 offset:11776
buffer_load_dwordx4 v[200:203], v2, s[36:39], s47 offen sc1
s_add_u32 s53, s47, 2048
buffer_load_dwordx4 v[204:207], v2, s[36:39], s47 offen offset:1024 sc1
s_cmp_ge_u32 s53, s64
s_cselect_b32 s47, s65, s53
v_mfma_f32_32x32x16_bf16 v[96:111], v[240:243], v[148:151], v[96:111]
v_mfma_f32_32x32x16_bf16 v[112:127], v[244:247], v[148:151], v[112:127]
s_waitcnt lgkmcnt(8)
s_waitcnt vmcnt(12)
v_mfma_f32_32x32x16_bf16 v[64:79], v[248:251], v[152:155], v[64:79]
v_mfma_f32_32x32x16_bf16 v[80:95], v[252:255], v[152:155], v[80:95]
ds_read_b64_tr_b16 v[240:241], v8 offset:12288
ds_read_b64_tr_b16 v[242:243], v8 offset:12800
ds_read_b64_tr_b16 v[244:245], v8 offset:13312
ds_read_b64_tr_b16 v[246:247], v8 offset:13824
buffer_load_dwordx4 v[208:211], v2, s[36:39], s47 offen sc1
s_add_u32 s53, s47, 2048
buffer_load_dwordx4 v[212:215], v2, s[36:39], s47 offen offset:1024 sc1
s_cmp_ge_u32 s53, s64
s_cselect_b32 s47, s65, s53
v_mfma_f32_32x32x16_bf16 v[96:111], v[248:251], v[156:159], v[96:111]
v_mfma_f32_32x32x16_bf16 v[112:127], v[252:255], v[156:159], v[112:127]
s_waitcnt lgkmcnt(8)
s_waitcnt vmcnt(12)
v_mfma_f32_32x32x16_bf16 v[64:79], v[224:227], v[160:163], v[64:79]
v_mfma_f32_32x32x16_bf16 v[80:95], v[228:231], v[160:163], v[80:95]
ds_read_b64_tr_b16 v[248:249], v9 offset:0
ds_read_b64_tr_b16 v[250:251], v9 offset:512
ds_read_b64_tr_b16 v[252:253], v9 offset:1024
ds_read_b64_tr_b16 v[254:255], v9 offset:1536
buffer_load_dwordx4 v[216:219], v2, s[36:39], s47 offen sc1
s_add_u32 s53, s47, 2048
buffer_load_dwordx4 v[220:223], v2, s[36:39], s47 offen offset:1024 sc1
s_cmp_ge_u32 s53, s64
s_cselect_b32 s47, s65, s53
v_mfma_f32_32x32x16_bf16 v[96:111], v[224:227], v[164:167], v[96:111]
v_mfma_f32_32x32x16_bf16 v[112:127], v[228:231], v[164:167], v[112:127]
s_waitcnt lgkmcnt(8)
s_waitcnt vmcnt(12)
v_mfma_f32_32x32x16_bf16 v[64:79], v[232:235], v[168:171], v[64:79]
v_mfma_f32_32x32x16_bf16 v[80:95], v[236:239], v[168:171], v[80:95]
ds_read_b64_tr_b16 v[224:225], v9 offset:2048
ds_read_b64_tr_b16 v[226:227], v9 offset:2560
ds_read_b64_tr_b16 v[228:229], v9 offset:3072
ds_read_b64_tr_b16 v[230:231], v9 offset:3584
buffer_load_dwordx4 v[128:131], v2, s[36:39], s47 offen sc1
s_add_u32 s53, s47, 2048
buffer_load_dwordx4 v[132:135], v2, s[36:39], s47 offen offset:1024 sc1
s_cmp_ge_u32 s53, s64
s_cselect_b32 s47, s65, s53
v_mfma_f32_32x32x16_bf16 v[96:111], v[232:235], v[172:175], v[96:111]
v_mfma_f32_32x32x16_bf16 v[112:127], v[236:239], v[172:175], v[112:127]
s_waitcnt lgkmcnt(8)
s_waitcnt vmcnt(12)
v_mfma_f32_32x32x16_bf16 v[64:79], v[240:243], v[176:179], v[64:79]
v_mfma_f32_32x32x16_bf16 v[80:95], v[244:247], v[176:179], v[80:95]
ds_read_b64_tr_b16 v[232:233], v9 offset:4096
ds_read_b64_tr_b16 v[234:235], v9 offset:4608
ds_read_b64_tr_b16 v[236:237], v9 offset:5120
ds_read_b64_tr_b16 v[238:239], v9 offset:5632
buffer_load_dwordx4 v[136:139], v2, s[36:39], s47 offen sc1
s_add_u32 s53, s47, 2048
buffer_load_dwordx4 v[140:143], v2, s[36:39], s47 offen offset:1024 sc1
s_cmp_ge_u32 s53, s64
s_cselect_b32 s47, s65, s53
v_mfma_f32_32x32x16_bf16 v[96:111], v[240:243], v[180:183], v[96:111]
v_mfma_f32_32x32x16_bf16 v[112:127], v[244:247], v[180:183], v[112:127]
s_waitcnt lgkmcnt(8)
s_waitcnt vmcnt(12)
v_mfma_f32_32x32x16_bf16 v[64:79], v[248:251], v[184:187], v[64:79]
v_mfma_f32_32x32x16_bf16 v[80:95], v[252:255], v[184:187], v[80:95]
ds_read_b64_tr_b16 v[240:241], v9 offset:24576
ds_read_b64_tr_b16 v[242:243], v9 offset:25088
ds_read_b64_tr_b16 v[244:245], v9 offset:25600
ds_read_b64_tr_b16 v[246:247], v9 offset:26112
buffer_load_dwordx4 v[144:147], v2, s[36:39], s47 offen sc1
s_add_u32 s53, s47, 2048
buffer_load_dwordx4 v[148:151], v2, s[36:39], s47 offen offset:1024 sc1
s_cmp_ge_u32 s53, s64
s_cselect_b32 s47, s65, s53
v_mfma_f32_32x32x16_bf16 v[96:111], v[248:251], v[188:191], v[96:111]
v_mfma_f32_32x32x16_bf16 v[112:127], v[252:255], v[188:191], v[112:127]
s_waitcnt lgkmcnt(8)
s_waitcnt vmcnt(12)
v_mfma_f32_32x32x16_bf16 v[64:79], v[224:227], v[192:195], v[64:79]
v_mfma_f32_32x32x16_bf16 v[80:95], v[228:231], v[192:195], v[80:95]
ds_read_b64_tr_b16 v[248:249], v9 offset:26624
ds_read_b64_tr_b16 v[250:251], v9 offset:27136
ds_read_b64_tr_b16 v[252:253], v9 offset:27648
ds_read_b64_tr_b16 v[254:255], v9 offset:28160
buffer_load_dwordx4 v[152:155], v2, s[36:39], s47 offen sc1
s_add_u32 s53, s47, 2048
buffer_load_dwordx4 v[156:159], v2, s[36:39], s47 offen offset:1024 sc1
s_cmp_ge_u32 s53, s64
s_cselect_b32 s47, s65, s53
v_mfma_f32_32x32x16_bf16 v[96:111], v[224:227], v[196:199], v[96:111]
v_mfma_f32_32x32x16_bf16 v[112:127], v[228:231], v[196:199], v[112:127]
s_waitcnt lgkmcnt(8)
s_waitcnt vmcnt(12)
v_mfma_f32_32x32x16_bf16 v[64:79], v[232:235], v[200:203], v[64:79]
v_mfma_f32_32x32x16_bf16 v[80:95], v[236:239], v[200:203], v[80:95]
ds_read_b64_tr_b16 v[224:225], v9 offset:28672
ds_read_b64_tr_b16 v[226:227], v9 offset:29184
ds_read_b64_tr_b16 v[228:229], v9 offset:29696
ds_read_b64_tr_b16 v[230:231], v9 offset:30208
buffer_load_dwordx4 v[160:163], v2, s[36:39], s47 offen sc1
s_add_u32 s53, s47, 2048
buffer_load_dwordx4 v[164:167], v2, s[36:39], s47 offen offset:1024 sc1
s_cmp_ge_u32 s53, s64
s_cselect_b32 s47, s65, s53
v_mfma_f32_32x32x16_bf16 v[96:111], v[232:235], v[204:207], v[96:111]
v_mfma_f32_32x32x16_bf16 v[112:127], v[236:239], v[204:207], v[112:127]
s_waitcnt lgkmcnt(8)
s_waitcnt vmcnt(12)
v_mfma_f32_32x32x16_bf16 v[64:79], v[240:243], v[208:211], v[64:79]
v_mfma_f32_32x32x16_bf16 v[80:95], v[244:247], v[208:211], v[80:95]
ds_read_b64_tr_b16 v[232:233], v10 offset:0
ds_read_b64_tr_b16 v[234:235], v10 offset:512
ds_read_b64_tr_b16 v[236:237], v10 offset:1024
ds_read_b64_tr_b16 v[238:239], v10 offset:1536
buffer_load_dwordx4 v[168:171], v2, s[36:39], s47 offen sc1
s_add_u32 s53, s47, 2048
buffer_load_dwordx4 v[172:175], v2, s[36:39], s47 offen offset:1024 sc1
s_cmp_ge_u32 s53, s64
s_cselect_b32 s47, s65, s53
v_mfma_f32_32x32x16_bf16 v[96:111], v[240:243], v[212:215], v[96:111]
v_mfma_f32_32x32x16_bf16 v[112:127], v[244:247], v[212:215], v[112:127]
s_waitcnt lgkmcnt(8)
s_waitcnt vmcnt(12)
v_mfma_f32_32x32x16_bf16 v[64:79], v[248:251], v[216:219], v[64:79]
v_mfma_f32_32x32x16_bf16 v[80:95], v[252:255], v[216:219], v[80:95]
ds_read_b64_tr_b16 v[240:241], v10 offset:2048
ds_read_b64_tr_b16 v[242:243], v10 offset:2560
ds_read_b64_tr_b16 v[244:245], v10 offset:3072
ds_read_b64_tr_b16 v[246:247], v10 offset:3584
buffer_load_dwordx4 v[176:179], v2, s[36:39], s47 offen sc1
s_add_u32 s53, s47, 2048
buffer_load_dwordx4 v[180:183], v2, s[36:39], s47 offen offset:1024 sc1
s_cmp_ge_u32 s53, s64
s_cselect_b32 s47, s65, s53
v_mfma_f32_32x32x16_bf16 v[96:111], v[248:251], v[220:223], v[96:111]
v_mfma_f32_32x32x16_bf16 v[112:127], v[252:255], v[220:223], v[112:127]
s_waitcnt lgkmcnt(8)
s_waitcnt vmcnt(12)
v_mfma_f32_32x32x16_bf16 v[64:79], v[224:227], v[128:131], v[64:79]
v_mfma_f32_32x32x16_bf16 v[80:95], v[228:231], v[128:131], v[80:95]
ds_read_b64_tr_b16 v[248:249], v10 offset:4096
ds_read_b64_tr_b16 v[250:251], v10 offset:4608
ds_read_b64_tr_b16 v[252:253], v10 offset:5120
ds_read_b64_tr_b16 v[254:255], v10 offset:5632
buffer_load_dwordx4 v[184:187], v2, s[36:39], s47 offen sc1
s_add_u32 s53, s47, 2048
buffer_load_dwordx4 v[188:191], v2, s[36:39], s47 offen offset:1024 sc1
s_cmp_ge_u32 s53, s64
s_cselect_b32 s47, s65, s53
v_mfma_f32_32x32x16_bf16 v[96:111], v[224:227], v[132:135], v[96:111]
v_mfma_f32_32x32x16_bf16 v[112:127], v[228:231], v[132:135], v[112:127]
s_waitcnt lgkmcnt(8)
s_waitcnt vmcnt(12)
v_mfma_f32_32x32x16_bf16 v[64:79], v[232:235], v[136:139], v[64:79]
v_mfma_f32_32x32x16_bf16 v[80:95], v[236:239], v[136:139], v[80:95]
ds_read_b64_tr_b16 v[224:225], v10 offset:6144
ds_read_b64_tr_b16 v[226:227], v10 offset:6656
ds_read_b64_tr_b16 v[228:229], v10 offset:7168
ds_read_b64_tr_b16 v[230:231], v10 offset:7680
buffer_load_dwordx4 v[192:195], v2, s[36:39], s47 offen sc1
s_add_u32 s53, s47, 2048
buffer_load_dwordx4 v[196:199], v2, s[36:39], s47 offen offset:1024 sc1
s_cmp_ge_u32 s53, s64
s_cselect_b32 s47, s65, s53
v_mfma_f32_32x32x16_bf16 v[96:111], v[232:235], v[140:143], v[96:111]
v_mfma_f32_32x32x16_bf16 v[112:127], v[236:239], v[140:143], v[112:127]
s_waitcnt lgkmcnt(8)
s_waitcnt vmcnt(12)
v_mfma_f32_32x32x16_bf16 v[64:79], v[240:243], v[144:147], v[64:79]
v_mfma_f32_32x32x16_bf16 v[80:95], v[244:247], v[144:147], v[80:95]
ds_read_b64_tr_b16 v[232:233], v10 offset:8192
ds_read_b64_tr_b16 v[234:235], v10 offset:8704
ds_read_b64_tr_b16 v[236:237], v10 offset:9216
ds_read_b64_tr_b16 v[238:239], v10 offset:9728
buffer_load_dwordx4 v[200:203], v2, s[36:39], s47 offen sc1
s_add_u32 s53, s47, 2048
buffer_load_dwordx4 v[204:207], v2, s[36:39], s47 offen offset:1024 sc1
s_cmp_ge_u32 s53, s64
s_cselect_b32 s47, s65, s53
v_mfma_f32_32x32x16_bf16 v[96:111], v[240:243], v[148:151], v[96:111]
v_mfma_f32_32x32x16_bf16 v[112:127], v[244:247], v[148:151], v[112:127]
s_waitcnt lgkmcnt(8)
s_waitcnt vmcnt(12)
v_mfma_f32_32x32x16_bf16 v[64:79], v[248:251], v[152:155], v[64:79]
v_mfma_f32_32x32x16_bf16 v[80:95], v[252:255], v[152:155], v[80:95]
ds_read_b64_tr_b16 v[240:241], v10 offset:10240
ds_read_b64_tr_b16 v[242:243], v10 offset:10752
ds_read_b64_tr_b16 v[244:245], v10 offset:11264
ds_read_b64_tr_b16 v[246:247], v10 offset:11776
v_mfma_f32_32x32x16_bf16 v[96:111], v[248:251], v[156:159], v[96:111]
v_mfma_f32_32x32x16_bf16 v[112:127], v[252:255], v[156:159], v[112:127]
s_waitcnt lgkmcnt(8)
s_waitcnt vmcnt(10)
v_mfma_f32_32x32x16_bf16 v[64:79], v[224:227], v[160:163], v[64:79]
v_mfma_f32_32x32x16_bf16 v[80:95], v[228:231], v[160:163], v[80:95]
ds_read_b64_tr_b16 v[248:249], v8 offset:0
ds_read_b64_tr_b16 v[250:251], v8 offset:512
ds_read_b64_tr_b16 v[252:253], v8 offset:1024
ds_read_b64_tr_b16 v[254:255], v8 offset:1536
v_mfma_f32_32x32x16_bf16 v[96:111], v[224:227], v[164:167], v[96:111]
v_mfma_f32_32x32x16_bf16 v[112:127], v[228:231], v[164:167], v[112:127]
s_waitcnt lgkmcnt(8)
s_waitcnt vmcnt(8)
v_mfma_f32_32x32x16_bf16 v[64:79], v[232:235], v[168:171], v[64:79]
v_mfma_f32_32x32x16_bf16 v[80:95], v[236:239], v[168:171], v[80:95]
ds_read_b64_tr_b16 v[224:225], v8 offset:2048
ds_read_b64_tr_b16 v[226:227], v8 offset:2560
ds_read_b64_tr_b16 v[228:229], v8 offset:3072
ds_read_b64_tr_b16 v[230:231], v8 offset:3584
v_mfma_f32_32x32x16_bf16 v[96:111], v[232:235], v[172:175], v[96:111]
v_mfma_f32_32x32x16_bf16 v[112:127], v[236:239], v[172:175], v[112:127]
s_waitcnt lgkmcnt(8)
s_waitcnt vmcnt(6)
v_mfma_f32_32x32x16_bf16 v[64:79], v[240:243], v[176:179], v[64:79]
v_mfma_f32_32x32x16_bf16 v[80:95], v[244:247], v[176:179], v[80:95]
ds_read_b64_tr_b16 v[232:233], v8 offset:4096
ds_read_b64_tr_b16 v[234:235], v8 offset:4608
ds_read_b64_tr_b16 v[236:237], v8 offset:5120
ds_read_b64_tr_b16 v[238:239], v8 offset:5632
v_mfma_f32_32x32x16_bf16 v[96:111], v[240:243], v[180:183], v[96:111]
v_mfma_f32_32x32x16_bf16 v[112:127], v[244:247], v[180:183], v[112:127]
s_waitcnt lgkmcnt(8)
s_waitcnt vmcnt(4)
v_mfma_f32_32x32x16_bf16 v[64:79], v[248:251], v[184:187], v[64:79]
v_mfma_f32_32x32x16_bf16 v[80:95], v[252:255], v[184:187], v[80:95]
v_mfma_f32_32x32x16_bf16 v[96:111], v[248:251], v[188:191], v[96:111]
v_mfma_f32_32x32x16_bf16 v[112:127], v[252:255], v[188:191], v[112:127]
s_waitcnt lgkmcnt(4)
s_waitcnt vmcnt(2)
v_mfma_f32_32x32x16_bf16 v[64:79], v[224:227], v[192:195], v[64:79]
v_mfma_f32_32x32x16_bf16 v[80:95], v[228:231], v[192:195], v[80:95]
v_mfma_f32_32x32x16_bf16 v[96:111], v[224:227], v[196:199], v[96:111]
v_mfma_f32_32x32x16_bf16 v[112:127], v[228:231], v[196:199], v[112:127]
s_waitcnt lgkmcnt(0)
s_waitcnt vmcnt(0)
v_mfma_f32_32x32x16_bf16 v[64:79], v[232:235], v[200:203], v[64:79]
v_mfma_f32_32x32x16_bf16 v[80:95], v[236:239], v[200:203], v[80:95]
v_mfma_f32_32x32x16_bf16 v[96:111], v[232:235], v[204:207], v[96:111]
v_mfma_f32_32x32x16_bf16 v[112:127], v[236:239], v[204:207], v[112:127]
s_nop 9
ds_write_b128 v13, v[64:67] offset:0
ds_write_b128 v13, v[68:71] offset:1024
ds_write_b128 v13, v[72:75] offset:2048
ds_write_b128 v13, v[76:79] offset:3072
ds_write_b128 v13, v[80:83] offset:4096
ds_write_b128 v13, v[84:87] offset:5120
ds_write_b128 v13, v[88:91] offset:6144
ds_write_b128 v13, v[92:95] offset:7168
ds_write_b128 v13, v[96:99] offset:8192
ds_write_b128 v13, v[100:103] offset:9216
ds_write_b128 v13, v[104:107] offset:10240
ds_write_b128 v13, v[108:111] offset:11264
ds_write_b128 v14, v[112:115] offset:0
ds_write_b128 v14, v[116:119] offset:1024
ds_write_b128 v14, v[120:123] offset:2048
ds_write_b128 v14, v[124:127] offset:3072
s_waitcnt lgkmcnt(0)
s_barrier
s_endpgm
LC:
v_pk_fma_f32 v[224:225], v[224:225], v[22:23], v[22:23] op_sel:[0,0,1] op_sel_hi:[1,0,1]
v_pk_fma_f32 v[226:227], v[226:227], v[22:23], v[22:23] op_sel:[0,0,1] op_sel_hi:[1,0,1]
v_pk_fma_f32 v[228:229], v[228:229], v[22:23], v[22:23] op_sel:[0,0,1] op_sel_hi:[1,0,1]
v_pk_fma_f32 v[230:231], v[230:231], v[22:23], v[22:23] op_sel:[0,0,1] op_sel_hi:[1,0,1]
v_cvt_pk_bf16_f32 v112, v224, v225
v_cvt_pk_bf16_f32 v113, v226, v227
v_cvt_pk_bf16_f32 v114, v228, v229
v_cvt_pk_bf16_f32 v115, v230, v231
ds_write_b128 v12, v[112:115] offset:4096
v_pk_fma_f32 v[232:233], v[232:233], v[24:25], v[24:25] op_sel:[0,0,1] op_sel_hi:[1,0,1]
v_pk_fma_f32 v[234:235], v[234:235], v[24:25], v[24:25] op_sel:[0,0,1] op_sel_hi:[1,0,1]
v_pk_fma_f32 v[236:237], v[236:237], v[24:25], v[24:25] op_sel:[0,0,1] op_sel_hi:[1,0,1]
v_pk_fma_f32 v[238:239], v[238:239], v[24:25], v[24:25] op_sel:[0,0,1] op_sel_hi:[1,0,1]
v_cvt_pk_bf16_f32 v116, v232, v233
v_cvt_pk_bf16_f32 v117, v234, v235
v_cvt_pk_bf16_f32 v118, v236, v237
v_cvt_pk_bf16_f32 v119, v238, v239
ds_write_b128 v13, v[116:119] offset:5120
v_pk_fma_f32 v[240:241], v[240:241], v[26:27], v[26:27] op_sel:[0,0,1] op_sel_hi:[1,0,1]
v_pk_fma_f32 v[242:243], v[242:243], v[26:27], v[26:27] op_sel:[0,0,1] op_sel_hi:[1,0,1]
v_pk_fma_f32 v[244:245], v[244:245], v[26:27], v[26:27] op_sel:[0,0,1] op_sel_hi:[1,0,1]
v_pk_fma_f32 v[246:247], v[246:247], v[26:27], v[26:27] op_sel:[0,0,1] op_sel_hi:[1,0,1]
v_cvt_pk_bf16_f32 v120, v240, v241
v_cvt_pk_bf16_f32 v121, v242, v243
v_cvt_pk_bf16_f32 v122, v244, v245
v_cvt_pk_bf16_f32 v123, v246, v247
ds_write_b128 v12, v[120:123] offset:6144
v_pk_fma_f32 v[248:249], v[248:249], v[28:29], v[28:29] op_sel:[0,0,1] op_sel_hi:[1,0,1]
v_pk_fma_f32 v[250:251], v[250:251], v[28:29], v[28:29] op_sel:[0,0,1] op_sel_hi:[1,0,1]
v_pk_fma_f32 v[252:253], v[252:253], v[28:29], v[28:29] op_sel:[0,0,1] op_sel_hi:[1,0,1]
v_pk_fma_f32 v[254:255], v[254:255], v[28:29], v[28:29] op_sel:[0,0,1] op_sel_hi:[1,0,1]
v_cvt_pk_bf16_f32 v124, v248, v249
v_cvt_pk_bf16_f32 v125, v250, v251
v_cvt_pk_bf16_f32 v126, v252, v253
v_cvt_pk_bf16_f32 v127, v254, v255
ds_write_b128 v13, v[124:127] offset:7168
ds_read_b128 v[232:235], v14 offset:4096
ds_read_b128 v[236:239], v15 offset:4096
ds_read_b128 v[240:243], v16 offset:4096
ds_read_b128 v[244:247], v17 offset:4096
v_pk_fma_f32 v[192:193], v[192:193], v[22:23], v[22:23] op_sel:[0,0,1] op_sel_hi:[1,0,1]
v_pk_fma_f32 v[194:195], v[194:195], v[22:23], v[22:23] op_sel:[0,0,1] op_sel_hi:[1,0,1]
v_pk_fma_f32 v[196:197], v[196:197], v[22:23], v[22:23] op_sel:[0,0,1] op_sel_hi:[1,0,1]
v_pk_fma_f32 v[198:199], v[198:199], v[22:23], v[22:23] op_sel:[0,0,1] op_sel_hi:[1,0,1]
v_cvt_pk_bf16_f32 v96, v192, v193
v_cvt_pk_bf16_f32 v97, v194, v195
v_cvt_pk_bf16_f32 v98, v196, v197
v_cvt_pk_bf16_f32 v99, v198, v199
ds_write_b128 v12, v[96:99] offset:0
v_pk_fma_f32 v[200:201], v[200:201], v[24:25], v[24:25] op_sel:[0,0,1] op_sel_hi:[1,0,1]
v_pk_fma_f32 v[202:203], v[202:203], v[24:25], v[24:25] op_sel:[0,0,1] op_sel_hi:[1,0,1]
v_pk_fma_f32 v[204:205], v[204:205], v[24:25], v[24:25] op_sel:[0,0,1] op_sel_hi:[1,0,1]
v_pk_fma_f32 v[206:207], v[206:207], v[24:25], v[24:25] op_sel:[0,0,1] op_sel_hi:[1,0,1]
v_cvt_pk_bf16_f32 v100, v200, v201
v_cvt_pk_bf16_f32 v101, v202, v203
v_cvt_pk_bf16_f32 v102, v204, v205
v_cvt_pk_bf16_f32 v103, v206, v207
ds_write_b128 v13, v[100:103] offset:1024
v_pk_fma_f32 v[208:209], v[208:209], v[26:27], v[26:27] op_sel:[0,0,1] op_sel_hi:[1,0,1]
v_pk_fma_f32 v[210:211], v[210:211], v[26:27], v[26:27] op_sel:[0,0,1] op_sel_hi:[1,0,1]
v_pk_fma_f32 v[212:213], v[212:213], v[26:27], v[26:27] op_sel:[0,0,1] op_sel_hi:[1,0,1]
v_pk_fma_f32 v[214:215], v[214:215], v[26:27], v[26:27] op_sel:[0,0,1] op_sel_hi:[1,0,1]
v_cvt_pk_bf16_f32 v104, v208, v209
v_cvt_pk_bf16_f32 v105, v210, v211
v_cvt_pk_bf16_f32 v106, v212, v213
v_cvt_pk_bf16_f32 v107, v214, v215
ds_write_b128 v12, v[104:107] offset:2048
v_pk_fma_f32 v[216:217], v[216:217], v[28:29], v[28:29] op_sel:[0,0,1] op_sel_hi:[1,0,1]
v_pk_fma_f32 v[218:219], v[218:219], v[28:29], v[28:29] op_sel:[0,0,1] op_sel_hi:[1,0,1]
v_pk_fma_f32 v[220:221], v[220:221], v[28:29], v[28:29] op_sel:[0,0,1] op_sel_hi:[1,0,1]
v_pk_fma_f32 v[222:223], v[222:223], v[28:29], v[28:29] op_sel:[0,0,1] op_sel_hi:[1,0,1]
v_cvt_pk_bf16_f32 v108, v216, v217
v_cvt_pk_bf16_f32 v109, v218, v219
v_cvt_pk_bf16_f32 v110, v220, v221
v_cvt_pk_bf16_f32 v111, v222, v223
ds_write_b128 v13, v[108:111] offset:3072
ds_read_b128 v[216:219], v14 offset:0
ds_read_b128 v[220:223], v15 offset:0
ds_read_b128 v[224:227], v16 offset:0
ds_read_b128 v[228:231], v17 offset:0
v_pk_fma_f32 v[160:161], v[160:161], v[22:23], v[22:23] op_sel:[0,0,1] op_sel_hi:[1,0,1]
v_pk_fma_f32 v[162:163], v[162:163], v[22:23], v[22:23] op_sel:[0,0,1] op_sel_hi:[1,0,1]
v_pk_fma_f32 v[164:165], v[164:165], v[22:23], v[22:23] op_sel:[0,0,1] op_sel_hi:[1,0,1]
v_pk_fma_f32 v[166:167], v[166:167], v[22:23], v[22:23] op_sel:[0,0,1] op_sel_hi:[1,0,1]
v_cvt_pk_bf16_f32 v80, v160, v161
v_cvt_pk_bf16_f32 v81, v162, v163
v_cvt_pk_bf16_f32 v82, v164, v165
v_cvt_pk_bf16_f32 v83, v166, v167
ds_write_b128 v12, v[80:83] offset:4096
v_pk_fma_f32 v[168:169], v[168:169], v[24:25], v[24:25] op_sel:[0,0,1] op_sel_hi:[1,0,1]
v_pk_fma_f32 v[170:171], v[170:171], v[24:25], v[24:25] op_sel:[0,0,1] op_sel_hi:[1,0,1]
v_pk_fma_f32 v[172:173], v[172:173], v[24:25], v[24:25] op_sel:[0,0,1] op_sel_hi:[1,0,1]
v_pk_fma_f32 v[174:175], v[174:175], v[24:25], v[24:25] op_sel:[0,0,1] op_sel_hi:[1,0,1]
v_cvt_pk_bf16_f32 v84, v168, v169
v_cvt_pk_bf16_f32 v85, v170, v171
v_cvt_pk_bf16_f32 v86, v172, v173
v_cvt_pk_bf16_f32 v87, v174, v175
ds_write_b128 v13, v[84:87] offset:5120
v_pk_fma_f32 v[176:177], v[176:177], v[26:27], v[26:27] op_sel:[0,0,1] op_sel_hi:[1,0,1]
v_pk_fma_f32 v[178:179], v[178:179], v[26:27], v[26:27] op_sel:[0,0,1] op_sel_hi:[1,0,1]
v_pk_fma_f32 v[180:181], v[180:181], v[26:27], v[26:27] op_sel:[0,0,1] op_sel_hi:[1,0,1]
v_pk_fma_f32 v[182:183], v[182:183], v[26:27], v[26:27] op_sel:[0,0,1] op_sel_hi:[1,0,1]
v_cvt_pk_bf16_f32 v88, v176, v177
v_cvt_pk_bf16_f32 v89, v178, v179
v_cvt_pk_bf16_f32 v90, v180, v181
v_cvt_pk_bf16_f32 v91, v182, v183
ds_write_b128 v12, v[88:91] offset:6144
v_pk_fma_f32 v[184:185], v[184:185], v[28:29], v[28:29] op_sel:[0,0,1] op_sel_hi:[1,0,1]
v_pk_fma_f32 v[186:187], v[186:187], v[28:29], v[28:29] op_sel:[0,0,1] op_sel_hi:[1,0,1]
v_pk_fma_f32 v[188:189], v[188:189], v[28:29], v[28:29] op_sel:[0,0,1] op_sel_hi:[1,0,1]
v_pk_fma_f32 v[190:191], v[190:191], v[28:29], v[28:29] op_sel:[0,0,1] op_sel_hi:[1,0,1]
v_cvt_pk_bf16_f32 v92, v184, v185
v_cvt_pk_bf16_f32 v93, v186, v187
v_cvt_pk_bf16_f32 v94, v188, v189
v_cvt_pk_bf16_f32 v95, v190, v191
ds_write_b128 v13, v[92:95] offset:7168
ds_read_b128 v[200:203], v14 offset:4096
ds_read_b128 v[204:207], v15 offset:4096
ds_read_b128 v[208:211], v16 offset:4096
ds_read_b128 v[212:215], v17 offset:4096
v_pk_fma_f32 v[128:129], v[128:129], v[22:23], v[22:23] op_sel:[0,0,1] op_sel_hi:[1,0,1]
v_pk_fma_f32 v[130:131], v[130:131], v[22:23], v[22:23] op_sel:[0,0,1] op_sel_hi:[1,0,1]
v_pk_fma_f32 v[132:133], v[132:133], v[22:23], v[22:23] op_sel:[0,0,1] op_sel_hi:[1,0,1]
v_pk_fma_f32 v[134:135], v[134:135], v[22:23], v[22:23] op_sel:[0,0,1] op_sel_hi:[1,0,1]
v_cvt_pk_bf16_f32 v64, v128, v129
v_cvt_pk_bf16_f32 v65, v130, v131
v_cvt_pk_bf16_f32 v66, v132, v133
v_cvt_pk_bf16_f32 v67, v134, v135
ds_write_b128 v12, v[64:67] offset:0
v_pk_fma_f32 v[136:137], v[136:137], v[24:25], v[24:25] op_sel:[0,0,1] op_sel_hi:[1,0,1]
v_pk_fma_f32 v[138:139], v[138:139], v[24:25], v[24:25] op_sel:[0,0,1] op_sel_hi:[1,0,1]
v_pk_fma_f32 v[140:141], v[140:141], v[24:25], v[24:25] op_sel:[0,0,1] op_sel_hi:[1,0,1]
v_pk_fma_f32 v[142:143], v[142:143], v[24:25], v[24:25] op_sel:[0,0,1] op_sel_hi:[1,0,1]
v_cvt_pk_bf16_f32 v68, v136, v137
v_cvt_pk_bf16_f32 v69, v138, v139
v_cvt_pk_bf16_f32 v70, v140, v141
v_cvt_pk_bf16_f32 v71, v142, v143
ds_write_b128 v13, v[68:71] offset:1024
v_pk_fma_f32 v[144:145], v[144:145], v[26:27], v[26:27] op_sel:[0,0,1] op_sel_hi:[1,0,1]
v_pk_fma_f32 v[146:147], v[146:147], v[26:27], v[26:27] op_sel:[0,0,1] op_sel_hi:[1,0,1]
v_pk_fma_f32 v[148:149], v[148:149], v[26:27], v[26:27] op_sel:[0,0,1] op_sel_hi:[1,0,1]
v_pk_fma_f32 v[150:151], v[150:151], v[26:27], v[26:27] op_sel:[0,0,1] op_sel_hi:[1,0,1]
v_cvt_pk_bf16_f32 v72, v144, v145
v_cvt_pk_bf16_f32 v73, v146, v147
v_cvt_pk_bf16_f32 v74, v148, v149
v_cvt_pk_bf16_f32 v75, v150, v151
ds_write_b128 v12, v[72:75] offset:2048
v_pk_fma_f32 v[152:153], v[152:153], v[28:29], v[28:29] op_sel:[0,0,1] op_sel_hi:[1,0,1]
v_pk_fma_f32 v[154:155], v[154:155], v[28:29], v[28:29] op_sel:[0,0,1] op_sel_hi:[1,0,1]
v_pk_fma_f32 v[156:157], v[156:157], v[28:29], v[28:29] op_sel:[0,0,1] op_sel_hi:[1,0,1]
v_pk_fma_f32 v[158:159], v[158:159], v[28:29], v[28:29] op_sel:[0,0,1] op_sel_hi:[1,0,1]
v_cvt_pk_bf16_f32 v76, v152, v153
v_cvt_pk_bf16_f32 v77, v154, v155
v_cvt_pk_bf16_f32 v78, v156, v157
v_cvt_pk_bf16_f32 v79, v158, v159
ds_write_b128 v13, v[76:79] offset:3072
ds_read_b128 v[184:187], v14 offset:0
ds_read_b128 v[188:191], v15 offset:0
ds_read_b128 v[192:195], v16 offset:0
ds_read_b128 v[196:199], v17 offset:0
s_waitcnt lgkmcnt(0)
s_waitcnt vmcnt(0)
s_barrier
s_setprio 1
ds_read_b128 v[176:179], v8 offset:0
ds_read_b64_tr_b16 v[128:129], v19 offset:0
ds_read_b64_tr_b16 v[130:131], v19 offset:256
ds_read_b64_tr_b16 v[132:133], v19 offset:3072
ds_read_b64_tr_b16 v[134:135], v19 offset:3328
ds_read_b64_tr_b16 v[136:137], v19 offset:1024
ds_read_b64_tr_b16 v[138:139], v19 offset:1280
ds_read_b64_tr_b16 v[140:141], v19 offset:4096
ds_read_b64_tr_b16 v[142:143], v19 offset:4352
ds_read_b64_tr_b16 v[144:145], v19 offset:2048
ds_read_b64_tr_b16 v[146:147], v19 offset:2304
ds_read_b64_tr_b16 v[148:149], v19 offset:5120
ds_read_b64_tr_b16 v[150:151], v19 offset:5376
s_and_b32 s60, s2, 7
s_lshl_b32 s60, s60, 2
s_lshr_b32 s9, s2, 6
s_add_u32 s60, s60, s9
s_waitcnt lgkmcnt(6)
v_mfma_f32_32x32x16_bf16 v[32:47], v[128:131], v[176:179], 0
ds_read_b128 v[180:183], v9 offset:0
ds_read_b64_tr_b16 v[152:153], v19 offset:6144
ds_read_b64_tr_b16 v[154:155], v19 offset:6400
v_mfma_f32_32x32x16_bf16 v[48:63], v[132:135], v[176:179], 0
ds_read_b64_tr_b16 v[156:157], v19 offset:9216
ds_read_b64_tr_b16 v[158:159], v19 offset:9472
v_mfma_f32_32x32x16_bf16 v[64:79], v[136:139], v[176:179], 0
ds_read_b64_tr_b16 v[160:161], v19 offset:7168
ds_read_b64_tr_b16 v[162:163], v19 offset:7424
s_waitcnt lgkmcnt(7)
v_mfma_f32_32x32x16_bf16 v[80:95], v[140:143], v[176:179], 0
ds_read_b64_tr_b16 v[164:165], v19 offset:10240
ds_read_b64_tr_b16 v[166:167], v19 offset:10496
v_mfma_f32_32x32x16_bf16 v[96:111], v[144:147], v[176:179], 0
ds_read_b64_tr_b16 v[168:169], v19 offset:8192
ds_read_b64_tr_b16 v[170:171], v19 offset:8448
v_mfma_f32_32x32x16_bf16 v[112:127], v[148:151], v[176:179], 0
ds_read_b64_tr_b16 v[172:173], v19 offset:11264
ds_read_b64_tr_b16 v[174:175], v19 offset:11520
s_waitcnt lgkmcnt(6)
v_mfma_f32_32x32x16_bf16 v[32:47], v[152:155], v[180:183], v[32:47]
ds_read_b128 v[176:179], v10 offset:0
ds_read_b64_tr_b16 v[128:129], v19 offset:12288
ds_read_b64_tr_b16 v[130:131], v19 offset:12544
v_mfma_f32_32x32x16_bf16 v[48:63], v[156:159], v[180:183], v[48:63]
ds_read_b64_tr_b16 v[132:133], v19 offset:15360
ds_read_b64_tr_b16 v[134:135], v19 offset:15616
v_mfma_f32_32x32x16_bf16 v[64:79], v[160:163], v[180:183], v[64:79]
ds_read_b64_tr_b16 v[136:137], v19 offset:13312
ds_read_b64_tr_b16 v[138:139], v19 offset:13568
s_waitcnt lgkmcnt(7)
v_mfma_f32_32x32x16_bf16 v[80:95], v[164:167], v[180:183], v[80:95]
ds_read_b64_tr_b16 v[140:141], v19 offset:16384
ds_read_b64_tr_b16 v[142:143], v19 offset:16640
v_mfma_f32_32x32x16_bf16 v[96:111], v[168:171], v[180:183], v[96:111]
ds_read_b64_tr_b16 v[144:145], v19 offset:14336
ds_read_b64_tr_b16 v[146:147], v19 offset:14592
v_mfma_f32_32x32x16_bf16 v[112:127], v[172:175], v[180:183], v[112:127]
ds_read_b64_tr_b16 v[148:149], v19 offset:17408
ds_read_b64_tr_b16 v[150:151], v19 offset:17664
s_waitcnt lgkmcnt(6)
v_mfma_f32_32x32x16_bf16 v[32:47], v[128:131], v[176:179], v[32:47]
ds_read_b128 v[180:183], v11 offset:0
ds_read_b64_tr_b16 v[152:153], v19 offset:18432
ds_read_b64_tr_b16 v[154:155], v19 offset:18688
v_mfma_f32_32x32x16_bf16 v[48:63], v[132:135], v[176:179], v[48:63]
ds_read_b64_tr_b16 v[156:157], v19 offset:21504
ds_read_b64_tr_b16 v[158:159], v19 offset:21760
v_mfma_f32_32x32x16_bf16 v[64:79], v[136:139], v[176:179], v[64:79]
ds_read_b64_tr_b16 v[160:161], v19 offset:19456
ds_read_b64_tr_b16 v[162:163], v19 offset:19712
s_waitcnt lgkmcnt(7)
v_mfma_f32_32x32x16_bf16 v[80:95], v[140:143], v[176:179], v[80:95]
ds_read_b64_tr_b16 v[164:165], v19 offset:22528
ds_read_b64_tr_b16 v[166:167], v19 offset:22784
v_mfma_f32_32x32x16_bf16 v[96:111], v[144:147], v[176:179], v[96:111]
ds_read_b64_tr_b16 v[168:169], v19 offset:20480
ds_read_b64_tr_b16 v[170:171], v19 offset:20736
v_mfma_f32_32x32x16_bf16 v[112:127], v[148:151], v[176:179], v[112:127]
ds_read_b64_tr_b16 v[172:173], v19 offset:23552
ds_read_b64_tr_b16 v[174:175], v19 offset:23808
s_waitcnt lgkmcnt(6)
v_mfma_f32_32x32x16_bf16 v[32:47], v[152:155], v[180:183], v[32:47]
s_barrier
ds_read_b128 v[176:179], v8 offset:16384
ds_read_b64_tr_b16 v[128:129], v19 offset:24576
ds_read_b64_tr_b16 v[130:131], v19 offset:24832
v_mfma_f32_32x32x16_bf16 v[48:63], v[156:159], v[180:183], v[48:63]
ds_read_b64_tr_b16 v[132:133], v19 offset:27648
ds_read_b64_tr_b16 v[134:135], v19 offset:27904
v_mfma_f32_32x32x16_bf16 v[64:79], v[160:163], v[180:183], v[64:79]
ds_read_b64_tr_b16 v[136:137], v19 offset:25600
ds_read_b64_tr_b16 v[138:139], v19 offset:25856
s_waitcnt lgkmcnt(7)
v_mfma_f32_32x32x16_bf16 v[80:95], v[164:167], v[180:183], v[80:95]
ds_read_b64_tr_b16 v[140:141], v19 offset:28672
ds_read_b64_tr_b16 v[142:143], v19 offset:28928
v_mfma_f32_32x32x16_bf16 v[96:111], v[168:171], v[180:183], v[96:111]
ds_read_b64_tr_b16 v[144:145], v19 offset:26624
ds_read_b64_tr_b16 v[146:147], v19 offset:26880
v_mfma_f32_32x32x16_bf16 v[112:127], v[172:175], v[180:183], v[112:127]
ds_read_b64_tr_b16 v[148:149], v19 offset:29696
ds_read_b64_tr_b16 v[150:151], v19 offset:29952
s_waitcnt lgkmcnt(6)
v_mfma_f32_32x32x16_bf16 v[32:47], v[128:131], v[176:179], v[32:47]
ds_read_b128 v[180:183], v9 offset:16384
ds_read_b64_tr_b16 v[152:153], v19 offset:30720
ds_read_b64_tr_b16 v[154:155], v19 offset:30976
v_mfma_f32_32x32x16_bf16 v[48:63], v[132:135], v[176:179], v[48:63]
ds_read_b64_tr_b16 v[156:157], v19 offset:33792
ds_read_b64_tr_b16 v[158:159], v19 offset:34048
v_mfma_f32_32x32x16_bf16 v[64:79], v[136:139], v[176:179], v[64:79]
ds_read_b64_tr_b16 v[160:161], v19 offset:31744
ds_read_b64_tr_b16 v[162:163], v19 offset:32000
s_waitcnt lgkmcnt(7)
v_mfma_f32_32x32x16_bf16 v[80:95], v[140:143], v[176:179], v[80:95]
ds_read_b64_tr_b16 v[164:165], v19 offset:34816
ds_read_b64_tr_b16 v[166:167], v19 offset:35072
v_mfma_f32_32x32x16_bf16 v[96:111], v[144:147], v[176:179], v[96:111]
ds_read_b64_tr_b16 v[168:169], v19 offset:32768
ds_read_b64_tr_b16 v[170:171], v19 offset:33024
v_mfma_f32_32x32x16_bf16 v[112:127], v[148:151], v[176:179], v[112:127]
ds_read_b64_tr_b16 v[172:173], v19 offset:35840
ds_read_b64_tr_b16 v[174:175], v19 offset:36096
s_waitcnt lgkmcnt(6)
v_mfma_f32_32x32x16_bf16 v[32:47], v[152:155], v[180:183], v[32:47]
ds_read_b128 v[176:179], v10 offset:16384
ds_read_b64_tr_b16 v[128:129], v19 offset:36864
ds_read_b64_tr_b16 v[130:131], v19 offset:37120
v_mfma_f32_32x32x16_bf16 v[48:63], v[156:159], v[180:183], v[48:63]
ds_read_b64_tr_b16 v[132:133], v19 offset:39936
ds_read_b64_tr_b16 v[134:135], v19 offset:40192
v_mfma_f32_32x32x16_bf16 v[64:79], v[160:163], v[180:183], v[64:79]
ds_read_b64_tr_b16 v[136:137], v19 offset:37888
ds_read_b64_tr_b16 v[138:139], v19 offset:38144
s_waitcnt lgkmcnt(7)
v_mfma_f32_32x32x16_bf16 v[80:95], v[164:167], v[180:183], v[80:95]
ds_read_b64_tr_b16 v[140:141], v19 offset:40960
ds_read_b64_tr_b16 v[142:143], v19 offset:41216
v_mfma_f32_32x32x16_bf16 v[96:111], v[168:171], v[180:183], v[96:111]
ds_read_b64_tr_b16 v[144:145], v19 offset:38912
ds_read_b64_tr_b16 v[146:147], v19 offset:39168
v_mfma_f32_32x32x16_bf16 v[112:127], v[172:175], v[180:183], v[112:127]
ds_read_b64_tr_b16 v[148:149], v19 offset:41984
ds_read_b64_tr_b16 v[150:151], v19 offset:42240
s_waitcnt lgkmcnt(6)
v_mfma_f32_32x32x16_bf16 v[32:47], v[128:131], v[176:179], v[32:47]
ds_read_b128 v[180:183], v11 offset:16384
ds_read_b64_tr_b16 v[152:153], v19 offset:43008
ds_read_b64_tr_b16 v[154:155], v19 offset:43264
v_mfma_f32_32x32x16_bf16 v[48:63], v[132:135], v[176:179], v[48:63]
ds_read_b64_tr_b16 v[156:157], v19 offset:46080
ds_read_b64_tr_b16 v[158:159], v19 offset:46336
v_mfma_f32_32x32x16_bf16 v[64:79], v[136:139], v[176:179], v[64:79]
ds_read_b64_tr_b16 v[160:161], v19 offset:44032
ds_read_b64_tr_b16 v[162:163], v19 offset:44288
s_waitcnt lgkmcnt(7)
v_mfma_f32_32x32x16_bf16 v[80:95], v[140:143], v[176:179], v[80:95]
ds_read_b64_tr_b16 v[164:165], v19 offset:47104
ds_read_b64_tr_b16 v[166:167], v19 offset:47360
v_mfma_f32_32x32x16_bf16 v[96:111], v[144:147], v[176:179], v[96:111]
ds_read_b64_tr_b16 v[168:169], v19 offset:45056
ds_read_b64_tr_b16 v[170:171], v19 offset:45312
v_mfma_f32_32x32x16_bf16 v[112:127], v[148:151], v[176:179], v[112:127]
ds_read_b64_tr_b16 v[172:173], v19 offset:48128
ds_read_b64_tr_b16 v[174:175], v19 offset:48384
s_waitcnt lgkmcnt(6)
v_mfma_f32_32x32x16_bf16 v[32:47], v[152:155], v[180:183], v[32:47]
s_barrier
ds_read_b128 v[176:179], v8 offset:32768
ds_read_b64_tr_b16 v[128:129], v21 offset:0
ds_read_b64_tr_b16 v[130:131], v21 offset:256
v_mfma_f32_32x32x16_bf16 v[48:63], v[156:159], v[180:183], v[48:63]
ds_read_b64_tr_b16 v[132:133], v21 offset:3072
ds_read_b64_tr_b16 v[134:135], v21 offset:3328
v_mfma_f32_32x32x16_bf16 v[64:79], v[160:163], v[180:183], v[64:79]
ds_read_b64_tr_b16 v[136:137], v21 offset:1024
ds_read_b64_tr_b16 v[138:139], v21 offset:1280
s_waitcnt lgkmcnt(7)
v_mfma_f32_32x32x16_bf16 v[80:95], v[164:167], v[180:183], v[80:95]
ds_read_b64_tr_b16 v[140:141], v21 offset:4096
ds_read_b64_tr_b16 v[142:143], v21 offset:4352
v_mfma_f32_32x32x16_bf16 v[96:111], v[168:171], v[180:183], v[96:111]
ds_read_b64_tr_b16 v[144:145], v21 offset:2048
ds_read_b64_tr_b16 v[146:147], v21 offset:2304
v_mfma_f32_32x32x16_bf16 v[112:127], v[172:175], v[180:183], v[112:127]
ds_read_b64_tr_b16 v[148:149], v21 offset:5120
ds_read_b64_tr_b16 v[150:151], v21 offset:5376
s_waitcnt lgkmcnt(6)
v_mfma_f32_32x32x16_bf16 v[32:47], v[128:131], v[176:179], v[32:47]
ds_read_b128 v[180:183], v9 offset:32768
ds_read_b64_tr_b16 v[152:153], v21 offset:6144
ds_read_b64_tr_b16 v[154:155], v21 offset:6400
v_mfma_f32_32x32x16_bf16 v[48:63], v[132:135], v[176:179], v[48:63]
ds_read_b64_tr_b16 v[156:157], v21 offset:9216
ds_read_b64_tr_b16 v[158:159], v21 offset:9472
v_mfma_f32_32x32x16_bf16 v[64:79], v[136:139], v[176:179], v[64:79]
ds_read_b64_tr_b16 v[160:161], v21 offset:7168
ds_read_b64_tr_b16 v[162:163], v21 offset:7424
s_waitcnt lgkmcnt(7)
v_mfma_f32_32x32x16_bf16 v[80:95], v[140:143], v[176:179], v[80:95]
ds_read_b64_tr_b16 v[164:165], v21 offset:10240
ds_read_b64_tr_b16 v[166:167], v21 offset:10496
v_mfma_f32_32x32x16_bf16 v[96:111], v[144:147], v[176:179], v[96:111]
ds_read_b64_tr_b16 v[168:169], v21 offset:8192
ds_read_b64_tr_b16 v[170:171], v21 offset:8448
v_mfma_f32_32x32x16_bf16 v[112:127], v[148:151], v[176:179], v[112:127]
ds_read_b64_tr_b16 v[172:173], v21 offset:11264
ds_read_b64_tr_b16 v[174:175], v21 offset:11520
s_waitcnt lgkmcnt(6)
v_mfma_f32_32x32x16_bf16 v[32:47], v[152:155], v[180:183], v[32:47]
ds_read_b128 v[176:179], v10 offset:32768
ds_read_b64_tr_b16 v[128:129], v21 offset:12288
ds_read_b64_tr_b16 v[130:131], v21 offset:12544
v_mfma_f32_32x32x16_bf16 v[48:63], v[156:159], v[180:183], v[48:63]
ds_read_b64_tr_b16 v[132:133], v21 offset:15360
ds_read_b64_tr_b16 v[134:135], v21 offset:15616
v_mfma_f32_32x32x16_bf16 v[64:79], v[160:163], v[180:183], v[64:79]
ds_read_b64_tr_b16 v[136:137], v21 offset:13312
ds_read_b64_tr_b16 v[138:139], v21 offset:13568
s_waitcnt lgkmcnt(7)
v_mfma_f32_32x32x16_bf16 v[80:95], v[164:167], v[180:183], v[80:95]
ds_read_b64_tr_b16 v[140:141], v21 offset:16384
ds_read_b64_tr_b16 v[142:143], v21 offset:16640
v_mfma_f32_32x32x16_bf16 v[96:111], v[168:171], v[180:183], v[96:111]
ds_read_b64_tr_b16 v[144:145], v21 offset:14336
ds_read_b64_tr_b16 v[146:147], v21 offset:14592
v_mfma_f32_32x32x16_bf16 v[112:127], v[172:175], v[180:183], v[112:127]
ds_read_b64_tr_b16 v[148:149], v21 offset:17408
ds_read_b64_tr_b16 v[150:151], v21 offset:17664
s_waitcnt lgkmcnt(6)
v_mfma_f32_32x32x16_bf16 v[32:47], v[128:131], v[176:179], v[32:47]
ds_read_b128 v[180:183], v11 offset:32768
ds_read_b64_tr_b16 v[152:153], v21 offset:18432
ds_read_b64_tr_b16 v[154:155], v21 offset:18688
v_mfma_f32_32x32x16_bf16 v[48:63], v[132:135], v[176:179], v[48:63]
ds_read_b64_tr_b16 v[156:157], v21 offset:21504
ds_read_b64_tr_b16 v[158:159], v21 offset:21760
v_mfma_f32_32x32x16_bf16 v[64:79], v[136:139], v[176:179], v[64:79]
ds_read_b64_tr_b16 v[160:161], v21 offset:19456
ds_read_b64_tr_b16 v[162:163], v21 offset:19712
s_waitcnt lgkmcnt(7)
v_mfma_f32_32x32x16_bf16 v[80:95], v[140:143], v[176:179], v[80:95]
ds_read_b64_tr_b16 v[164:165], v21 offset:22528
ds_read_b64_tr_b16 v[166:167], v21 offset:22784
v_mfma_f32_32x32x16_bf16 v[96:111], v[144:147], v[176:179], v[96:111]
ds_read_b64_tr_b16 v[168:169], v21 offset:20480
ds_read_b64_tr_b16 v[170:171], v21 offset:20736
v_mfma_f32_32x32x16_bf16 v[112:127], v[148:151], v[176:179], v[112:127]
ds_read_b64_tr_b16 v[172:173], v21 offset:23552
ds_read_b64_tr_b16 v[174:175], v21 offset:23808
s_waitcnt lgkmcnt(6)
v_mfma_f32_32x32x16_bf16 v[32:47], v[152:155], v[180:183], v[32:47]
s_barrier
ds_read_b128 v[176:179], v8 offset:49152
ds_read_b64_tr_b16 v[128:129], v21 offset:24576
ds_read_b64_tr_b16 v[130:131], v21 offset:24832
v_mfma_f32_32x32x16_bf16 v[48:63], v[156:159], v[180:183], v[48:63]
ds_read_b64_tr_b16 v[132:133], v21 offset:27648
ds_read_b64_tr_b16 v[134:135], v21 offset:27904
v_mfma_f32_32x32x16_bf16 v[64:79], v[160:163], v[180:183], v[64:79]
ds_read_b64_tr_b16 v[136:137], v21 offset:25600
ds_read_b64_tr_b16 v[138:139], v21 offset:25856
s_waitcnt lgkmcnt(7)
v_mfma_f32_32x32x16_bf16 v[80:95], v[164:167], v[180:183], v[80:95]
ds_read_b64_tr_b16 v[140:141], v21 offset:28672
ds_read_b64_tr_b16 v[142:143], v21 offset:28928
v_mfma_f32_32x32x16_bf16 v[96:111], v[168:171], v[180:183], v[96:111]
ds_read_b64_tr_b16 v[144:145], v21 offset:26624
ds_read_b64_tr_b16 v[146:147], v21 offset:26880
v_mfma_f32_32x32x16_bf16 v[112:127], v[172:175], v[180:183], v[112:127]
ds_read_b64_tr_b16 v[148:149], v21 offset:29696
ds_read_b64_tr_b16 v[150:151], v21 offset:29952
s_waitcnt lgkmcnt(6)
v_mfma_f32_32x32x16_bf16 v[32:47], v[128:131], v[176:179], v[32:47]
ds_read_b128 v[180:183], v9 offset:49152
ds_read_b64_tr_b16 v[152:153], v21 offset:30720
ds_read_b64_tr_b16 v[154:155], v21 offset:30976
v_mfma_f32_32x32x16_bf16 v[48:63], v[132:135], v[176:179], v[48:63]
ds_read_b64_tr_b16 v[156:157], v21 offset:33792
ds_read_b64_tr_b16 v[158:159], v21 offset:34048
v_mfma_f32_32x32x16_bf16 v[64:79], v[136:139], v[176:179], v[64:79]
ds_read_b64_tr_b16 v[160:161], v21 offset:31744
ds_read_b64_tr_b16 v[162:163], v21 offset:32000
s_waitcnt lgkmcnt(7)
v_mfma_f32_32x32x16_bf16 v[80:95], v[140:143], v[176:179], v[80:95]
ds_read_b64_tr_b16 v[164:165], v21 offset:34816
ds_read_b64_tr_b16 v[166:167], v21 offset:35072
v_mfma_f32_32x32x16_bf16 v[96:111], v[144:147], v[176:179], v[96:111]
ds_read_b64_tr_b16 v[168:169], v21 offset:32768
ds_read_b64_tr_b16 v[170:171], v21 offset:33024
v_mfma_f32_32x32x16_bf16 v[112:127], v[148:151], v[176:179], v[112:127]
ds_read_b64_tr_b16 v[172:173], v21 offset:35840
ds_read_b64_tr_b16 v[174:175], v21 offset:36096
s_waitcnt lgkmcnt(6)
v_mfma_f32_32x32x16_bf16 v[32:47], v[152:155], v[180:183], v[32:47]
ds_read_b128 v[176:179], v10 offset:49152
ds_read_b64_tr_b16 v[128:129], v21 offset:36864
ds_read_b64_tr_b16 v[130:131], v21 offset:37120
v_mfma_f32_32x32x16_bf16 v[48:63], v[156:159], v[180:183], v[48:63]
ds_read_b64_tr_b16 v[132:133], v21 offset:39936
ds_read_b64_tr_b16 v[134:135], v21 offset:40192
v_mfma_f32_32x32x16_bf16 v[64:79], v[160:163], v[180:183], v[64:79]
ds_read_b64_tr_b16 v[136:137], v21 offset:37888
ds_read_b64_tr_b16 v[138:139], v21 offset:38144
s_waitcnt lgkmcnt(7)
v_mfma_f32_32x32x16_bf16 v[80:95], v[164:167], v[180:183], v[80:95]
ds_read_b64_tr_b16 v[140:141], v21 offset:40960
ds_read_b64_tr_b16 v[142:143], v21 offset:41216
v_mfma_f32_32x32x16_bf16 v[96:111], v[168:171], v[180:183], v[96:111]
ds_read_b64_tr_b16 v[144:145], v21 offset:38912
ds_read_b64_tr_b16 v[146:147], v21 offset:39168
v_mfma_f32_32x32x16_bf16 v[112:127], v[172:175], v[180:183], v[112:127]
ds_read_b64_tr_b16 v[148:149], v21 offset:41984
ds_read_b64_tr_b16 v[150:151], v21 offset:42240
s_waitcnt lgkmcnt(6)
v_mfma_f32_32x32x16_bf16 v[32:47], v[128:131], v[176:179], v[32:47]
ds_read_b128 v[180:183], v11 offset:49152
ds_read_b64_tr_b16 v[152:153], v21 offset:43008
ds_read_b64_tr_b16 v[154:155], v21 offset:43264
v_mfma_f32_32x32x16_bf16 v[48:63], v[132:135], v[176:179], v[48:63]
ds_read_b64_tr_b16 v[156:157], v21 offset:46080
ds_read_b64_tr_b16 v[158:159], v21 offset:46336
v_mfma_f32_32x32x16_bf16 v[64:79], v[136:139], v[176:179], v[64:79]
ds_read_b64_tr_b16 v[160:161], v21 offset:44032
ds_read_b64_tr_b16 v[162:163], v21 offset:44288
s_waitcnt lgkmcnt(7)
v_mfma_f32_32x32x16_bf16 v[80:95], v[140:143], v[176:179], v[80:95]
ds_read_b64_tr_b16 v[164:165], v21 offset:47104
ds_read_b64_tr_b16 v[166:167], v21 offset:47360
v_mfma_f32_32x32x16_bf16 v[96:111], v[144:147], v[176:179], v[96:111]
ds_read_b64_tr_b16 v[168:169], v21 offset:45056
ds_read_b64_tr_b16 v[170:171], v21 offset:45312
v_mfma_f32_32x32x16_bf16 v[112:127], v[148:151], v[176:179], v[112:127]
ds_read_b64_tr_b16 v[172:173], v21 offset:48128
ds_read_b64_tr_b16 v[174:175], v21 offset:48384
s_waitcnt lgkmcnt(6)
v_mfma_f32_32x32x16_bf16 v[32:47], v[152:155], v[180:183], v[32:47]
s_barrier
ds_read_b64_tr_b16 v[128:129], v19 offset:0
ds_read_b64_tr_b16 v[130:131], v19 offset:256
v_mfma_f32_32x32x16_bf16 v[48:63], v[156:159], v[180:183], v[48:63]
ds_read_b64_tr_b16 v[132:133], v19 offset:3072
ds_read_b64_tr_b16 v[134:135], v19 offset:3328
v_mfma_f32_32x32x16_bf16 v[64:79], v[160:163], v[180:183], v[64:79]
ds_read_b64_tr_b16 v[136:137], v19 offset:1024
ds_read_b64_tr_b16 v[138:139], v19 offset:1280
s_waitcnt lgkmcnt(6)
v_mfma_f32_32x32x16_bf16 v[80:95], v[164:167], v[180:183], v[80:95]
ds_read_b64_tr_b16 v[140:141], v19 offset:4096
ds_read_b64_tr_b16 v[142:143], v19 offset:4352
v_mfma_f32_32x32x16_bf16 v[96:111], v[168:171], v[180:183], v[96:111]
ds_read_b64_tr_b16 v[144:145], v19 offset:2048
ds_read_b64_tr_b16 v[146:147], v19 offset:2304
v_mfma_f32_32x32x16_bf16 v[112:127], v[172:175], v[180:183], v[112:127]
ds_read_b64_tr_b16 v[148:149], v19 offset:5120
ds_read_b64_tr_b16 v[150:151], v19 offset:5376
s_waitcnt lgkmcnt(6)
v_mfma_f32_32x32x16_bf16 v[32:47], v[128:131], v[184:187], v[32:47]
ds_read_b64_tr_b16 v[152:153], v19 offset:6144
ds_read_b64_tr_b16 v[154:155], v19 offset:6400
v_mfma_f32_32x32x16_bf16 v[48:63], v[132:135], v[184:187], v[48:63]
ds_read_b64_tr_b16 v[156:157], v19 offset:9216
ds_read_b64_tr_b16 v[158:159], v19 offset:9472
v_mfma_f32_32x32x16_bf16 v[64:79], v[136:139], v[184:187], v[64:79]
ds_read_b64_tr_b16 v[160:161], v19 offset:7168
ds_read_b64_tr_b16 v[162:163], v19 offset:7424
s_waitcnt lgkmcnt(6)
v_mfma_f32_32x32x16_bf16 v[80:95], v[140:143], v[184:187], v[80:95]
ds_read_b64_tr_b16 v[164:165], v19 offset:10240
ds_read_b64_tr_b16 v[166:167], v19 offset:10496
v_mfma_f32_32x32x16_bf16 v[96:111], v[144:147], v[184:187], v[96:111]
ds_read_b64_tr_b16 v[168:169], v19 offset:8192
ds_read_b64_tr_b16 v[170:171], v19 offset:8448
v_mfma_f32_32x32x16_bf16 v[112:127], v[148:151], v[184:187], v[112:127]
ds_read_b64_tr_b16 v[172:173], v19 offset:11264
ds_read_b64_tr_b16 v[174:175], v19 offset:11520
s_waitcnt lgkmcnt(6)
v_mfma_f32_32x32x16_bf16 v[32:47], v[152:155], v[188:191], v[32:47]
ds_read_b64_tr_b16 v[128:129], v19 offset:12288
ds_read_b64_tr_b16 v[130:131], v19 offset:12544
v_mfma_f32_32x32x16_bf16 v[48:63], v[156:159], v[188:191], v[48:63]
ds_read_b64_tr_b16 v[132:133], v19 offset:15360
ds_read_b64_tr_b16 v[134:135], v19 offset:15616
v_mfma_f32_32x32x16_bf16 v[64:79], v[160:163], v[188:191], v[64:79]
ds_read_b64_tr_b16 v[136:137], v19 offset:13312
ds_read_b64_tr_b16 v[138:139], v19 offset:13568
s_waitcnt lgkmcnt(6)
v_mfma_f32_32x32x16_bf16 v[80:95], v[164:167], v[188:191], v[80:95]
ds_read_b64_tr_b16 v[140:141], v19 offset:16384
ds_read_b64_tr_b16 v[142:143], v19 offset:16640
v_mfma_f32_32x32x16_bf16 v[96:111], v[168:171], v[188:191], v[96:111]
ds_read_b64_tr_b16 v[144:145], v19 offset:14336
ds_read_b64_tr_b16 v[146:147], v19 offset:14592
v_mfma_f32_32x32x16_bf16 v[112:127], v[172:175], v[188:191], v[112:127]
ds_read_b64_tr_b16 v[148:149], v19 offset:17408
ds_read_b64_tr_b16 v[150:151], v19 offset:17664
s_waitcnt lgkmcnt(6)
v_mfma_f32_32x32x16_bf16 v[32:47], v[128:131], v[192:195], v[32:47]
ds_read_b64_tr_b16 v[152:153], v19 offset:18432
ds_read_b64_tr_b16 v[154:155], v19 offset:18688
v_mfma_f32_32x32x16_bf16 v[48:63], v[132:135], v[192:195], v[48:63]
ds_read_b64_tr_b16 v[156:157], v19 offset:21504
ds_read_b64_tr_b16 v[158:159], v19 offset:21760
v_mfma_f32_32x32x16_bf16 v[64:79], v[136:139], v[192:195], v[64:79]
ds_read_b64_tr_b16 v[160:161], v19 offset:19456
ds_read_b64_tr_b16 v[162:163], v19 offset:19712
s_waitcnt lgkmcnt(6)
v_mfma_f32_32x32x16_bf16 v[80:95], v[140:143], v[192:195], v[80:95]
ds_read_b64_tr_b16 v[164:165], v19 offset:22528
ds_read_b64_tr_b16 v[166:167], v19 offset:22784
v_mfma_f32_32x32x16_bf16 v[96:111], v[144:147], v[192:195], v[96:111]
ds_read_b64_tr_b16 v[168:169], v19 offset:20480
ds_read_b64_tr_b16 v[170:171], v19 offset:20736
v_mfma_f32_32x32x16_bf16 v[112:127], v[148:151], v[192:195], v[112:127]
ds_read_b64_tr_b16 v[172:173], v19 offset:23552
ds_read_b64_tr_b16 v[174:175], v19 offset:23808
s_waitcnt lgkmcnt(6)
v_mfma_f32_32x32x16_bf16 v[32:47], v[152:155], v[196:199], v[32:47]
s_barrier
ds_read_b64_tr_b16 v[128:129], v19 offset:24576
ds_read_b64_tr_b16 v[130:131], v19 offset:24832
v_mfma_f32_32x32x16_bf16 v[48:63], v[156:159], v[196:199], v[48:63]
ds_read_b64_tr_b16 v[132:133], v19 offset:27648
ds_read_b64_tr_b16 v[134:135], v19 offset:27904
v_mfma_f32_32x32x16_bf16 v[64:79], v[160:163], v[196:199], v[64:79]
ds_read_b64_tr_b16 v[136:137], v19 offset:25600
ds_read_b64_tr_b16 v[138:139], v19 offset:25856
s_waitcnt lgkmcnt(6)
v_mfma_f32_32x32x16_bf16 v[80:95], v[164:167], v[196:199], v[80:95]
ds_read_b64_tr_b16 v[140:141], v19 offset:28672
ds_read_b64_tr_b16 v[142:143], v19 offset:28928
v_mfma_f32_32x32x16_bf16 v[96:111], v[168:171], v[196:199], v[96:111]
ds_read_b64_tr_b16 v[144:145], v19 offset:26624
ds_read_b64_tr_b16 v[146:147], v19 offset:26880
v_mfma_f32_32x32x16_bf16 v[112:127], v[172:175], v[196:199], v[112:127]
ds_read_b64_tr_b16 v[148:149], v19 offset:29696
ds_read_b64_tr_b16 v[150:151], v19 offset:29952
s_waitcnt lgkmcnt(6)
v_mfma_f32_32x32x16_bf16 v[32:47], v[128:131], v[200:203], v[32:47]
ds_read_b64_tr_b16 v[152:153], v19 offset:30720
ds_read_b64_tr_b16 v[154:155], v19 offset:30976
v_mfma_f32_32x32x16_bf16 v[48:63], v[132:135], v[200:203], v[48:63]
ds_read_b64_tr_b16 v[156:157], v19 offset:33792
ds_read_b64_tr_b16 v[158:159], v19 offset:34048
v_mfma_f32_32x32x16_bf16 v[64:79], v[136:139], v[200:203], v[64:79]
ds_read_b64_tr_b16 v[160:161], v19 offset:31744
ds_read_b64_tr_b16 v[162:163], v19 offset:32000
s_waitcnt lgkmcnt(6)
v_mfma_f32_32x32x16_bf16 v[80:95], v[140:143], v[200:203], v[80:95]
ds_read_b64_tr_b16 v[164:165], v19 offset:34816
ds_read_b64_tr_b16 v[166:167], v19 offset:35072
v_mfma_f32_32x32x16_bf16 v[96:111], v[144:147], v[200:203], v[96:111]
ds_read_b64_tr_b16 v[168:169], v19 offset:32768
ds_read_b64_tr_b16 v[170:171], v19 offset:33024
v_mfma_f32_32x32x16_bf16 v[112:127], v[148:151], v[200:203], v[112:127]
ds_read_b64_tr_b16 v[172:173], v19 offset:35840
ds_read_b64_tr_b16 v[174:175], v19 offset:36096
s_waitcnt lgkmcnt(6)
v_mfma_f32_32x32x16_bf16 v[32:47], v[152:155], v[204:207], v[32:47]
ds_read_b64_tr_b16 v[128:129], v19 offset:36864
ds_read_b64_tr_b16 v[130:131], v19 offset:37120
v_mfma_f32_32x32x16_bf16 v[48:63], v[156:159], v[204:207], v[48:63]
ds_read_b64_tr_b16 v[132:133], v19 offset:39936
ds_read_b64_tr_b16 v[134:135], v19 offset:40192
v_mfma_f32_32x32x16_bf16 v[64:79], v[160:163], v[204:207], v[64:79]
ds_read_b64_tr_b16 v[136:137], v19 offset:37888
ds_read_b64_tr_b16 v[138:139], v19 offset:38144
s_waitcnt lgkmcnt(6)
v_mfma_f32_32x32x16_bf16 v[80:95], v[164:167], v[204:207], v[80:95]
ds_read_b64_tr_b16 v[140:141], v19 offset:40960
ds_read_b64_tr_b16 v[142:143], v19 offset:41216
v_mfma_f32_32x32x16_bf16 v[96:111], v[168:171], v[204:207], v[96:111]
ds_read_b64_tr_b16 v[144:145], v19 offset:38912
ds_read_b64_tr_b16 v[146:147], v19 offset:39168
v_mfma_f32_32x32x16_bf16 v[112:127], v[172:175], v[204:207], v[112:127]
ds_read_b64_tr_b16 v[148:149], v19 offset:41984
ds_read_b64_tr_b16 v[150:151], v19 offset:42240
s_waitcnt lgkmcnt(6)
v_mfma_f32_32x32x16_bf16 v[32:47], v[128:131], v[208:211], v[32:47]
ds_read_b64_tr_b16 v[152:153], v19 offset:43008
ds_read_b64_tr_b16 v[154:155], v19 offset:43264
v_mfma_f32_32x32x16_bf16 v[48:63], v[132:135], v[208:211], v[48:63]
ds_read_b64_tr_b16 v[156:157], v19 offset:46080
ds_read_b64_tr_b16 v[158:159], v19 offset:46336
v_mfma_f32_32x32x16_bf16 v[64:79], v[136:139], v[208:211], v[64:79]
ds_read_b64_tr_b16 v[160:161], v19 offset:44032
ds_read_b64_tr_b16 v[162:163], v19 offset:44288
s_waitcnt lgkmcnt(6)
v_mfma_f32_32x32x16_bf16 v[80:95], v[140:143], v[208:211], v[80:95]
ds_read_b64_tr_b16 v[164:165], v19 offset:47104
ds_read_b64_tr_b16 v[166:167], v19 offset:47360
v_mfma_f32_32x32x16_bf16 v[96:111], v[144:147], v[208:211], v[96:111]
ds_read_b64_tr_b16 v[168:169], v19 offset:45056
ds_read_b64_tr_b16 v[170:171], v19 offset:45312
v_mfma_f32_32x32x16_bf16 v[112:127], v[148:151], v[208:211], v[112:127]
ds_read_b64_tr_b16 v[172:173], v19 offset:48128
ds_read_b64_tr_b16 v[174:175], v19 offset:48384
s_waitcnt lgkmcnt(6)
v_mfma_f32_32x32x16_bf16 v[32:47], v[152:155], v[212:215], v[32:47]
s_barrier
ds_read_b64_tr_b16 v[128:129], v21 offset:0
ds_read_b64_tr_b16 v[130:131], v21 offset:256
v_mfma_f32_32x32x16_bf16 v[48:63], v[156:159], v[212:215], v[48:63]
ds_read_b64_tr_b16 v[132:133], v21 offset:3072
ds_read_b64_tr_b16 v[134:135], v21 offset:3328
v_mfma_f32_32x32x16_bf16 v[64:79], v[160:163], v[212:215], v[64:79]
ds_read_b64_tr_b16 v[136:137], v21 offset:1024
ds_read_b64_tr_b16 v[138:139], v21 offset:1280
s_waitcnt lgkmcnt(6)
v_mfma_f32_32x32x16_bf16 v[80:95], v[164:167], v[212:215], v[80:95]
ds_read_b64_tr_b16 v[140:141], v21 offset:4096
ds_read_b64_tr_b16 v[142:143], v21 offset:4352
v_mfma_f32_32x32x16_bf16 v[96:111], v[168:171], v[212:215], v[96:111]
ds_read_b64_tr_b16 v[144:145], v21 offset:2048
ds_read_b64_tr_b16 v[146:147], v21 offset:2304
v_mfma_f32_32x32x16_bf16 v[112:127], v[172:175], v[212:215], v[112:127]
ds_read_b64_tr_b16 v[148:149], v21 offset:5120
ds_read_b64_tr_b16 v[150:151], v21 offset:5376
s_waitcnt lgkmcnt(6)
v_mfma_f32_32x32x16_bf16 v[32:47], v[128:131], v[216:219], v[32:47]
ds_read_b64_tr_b16 v[152:153], v21 offset:6144
ds_read_b64_tr_b16 v[154:155], v21 offset:6400
v_mfma_f32_32x32x16_bf16 v[48:63], v[132:135], v[216:219], v[48:63]
ds_read_b64_tr_b16 v[156:157], v21 offset:9216
ds_read_b64_tr_b16 v[158:159], v21 offset:9472
v_mfma_f32_32x32x16_bf16 v[64:79], v[136:139], v[216:219], v[64:79]
ds_read_b64_tr_b16 v[160:161], v21 offset:7168
ds_read_b64_tr_b16 v[162:163], v21 offset:7424
s_waitcnt lgkmcnt(6)
v_mfma_f32_32x32x16_bf16 v[80:95], v[140:143], v[216:219], v[80:95]
ds_read_b64_tr_b16 v[164:165], v21 offset:10240
ds_read_b64_tr_b16 v[166:167], v21 offset:10496
v_mfma_f32_32x32x16_bf16 v[96:111], v[144:147], v[216:219], v[96:111]
ds_read_b64_tr_b16 v[168:169], v21 offset:8192
ds_read_b64_tr_b16 v[170:171], v21 offset:8448
v_mfma_f32_32x32x16_bf16 v[112:127], v[148:151], v[216:219], v[112:127]
ds_read_b64_tr_b16 v[172:173], v21 offset:11264
ds_read_b64_tr_b16 v[174:175], v21 offset:11520
s_waitcnt lgkmcnt(6)
v_mfma_f32_32x32x16_bf16 v[32:47], v[152:155], v[220:223], v[32:47]
ds_read_b64_tr_b16 v[128:129], v21 offset:12288
ds_read_b64_tr_b16 v[130:131], v21 offset:12544
v_mfma_f32_32x32x16_bf16 v[48:63], v[156:159], v[220:223], v[48:63]
ds_read_b64_tr_b16 v[132:133], v21 offset:15360
ds_read_b64_tr_b16 v[134:135], v21 offset:15616
v_mfma_f32_32x32x16_bf16 v[64:79], v[160:163], v[220:223], v[64:79]
ds_read_b64_tr_b16 v[136:137], v21 offset:13312
ds_read_b64_tr_b16 v[138:139], v21 offset:13568
s_waitcnt lgkmcnt(6)
v_mfma_f32_32x32x16_bf16 v[80:95], v[164:167], v[220:223], v[80:95]
ds_read_b64_tr_b16 v[140:141], v21 offset:16384
ds_read_b64_tr_b16 v[142:143], v21 offset:16640
v_mfma_f32_32x32x16_bf16 v[96:111], v[168:171], v[220:223], v[96:111]
ds_read_b64_tr_b16 v[144:145], v21 offset:14336
ds_read_b64_tr_b16 v[146:147], v21 offset:14592
v_mfma_f32_32x32x16_bf16 v[112:127], v[172:175], v[220:223], v[112:127]
ds_read_b64_tr_b16 v[148:149], v21 offset:17408
ds_read_b64_tr_b16 v[150:151], v21 offset:17664
s_waitcnt lgkmcnt(6)
v_mfma_f32_32x32x16_bf16 v[32:47], v[128:131], v[224:227], v[32:47]
ds_read_b64_tr_b16 v[152:153], v21 offset:18432
ds_read_b64_tr_b16 v[154:155], v21 offset:18688
v_mfma_f32_32x32x16_bf16 v[48:63], v[132:135], v[224:227], v[48:63]
ds_read_b64_tr_b16 v[156:157], v21 offset:21504
ds_read_b64_tr_b16 v[158:159], v21 offset:21760
v_mfma_f32_32x32x16_bf16 v[64:79], v[136:139], v[224:227], v[64:79]
ds_read_b64_tr_b16 v[160:161], v21 offset:19456
ds_read_b64_tr_b16 v[162:163], v21 offset:19712
s_waitcnt lgkmcnt(6)
v_mfma_f32_32x32x16_bf16 v[80:95], v[140:143], v[224:227], v[80:95]
ds_read_b64_tr_b16 v[164:165], v21 offset:22528
ds_read_b64_tr_b16 v[166:167], v21 offset:22784
v_mfma_f32_32x32x16_bf16 v[96:111], v[144:147], v[224:227], v[96:111]
ds_read_b64_tr_b16 v[168:169], v21 offset:20480
ds_read_b64_tr_b16 v[170:171], v21 offset:20736
v_mfma_f32_32x32x16_bf16 v[112:127], v[148:151], v[224:227], v[112:127]
ds_read_b64_tr_b16 v[172:173], v21 offset:23552
ds_read_b64_tr_b16 v[174:175], v21 offset:23808
s_waitcnt lgkmcnt(6)
v_mfma_f32_32x32x16_bf16 v[32:47], v[152:155], v[228:231], v[32:47]
s_barrier
ds_read_b64_tr_b16 v[128:129], v21 offset:24576
ds_read_b64_tr_b16 v[130:131], v21 offset:24832
v_mfma_f32_32x32x16_bf16 v[48:63], v[156:159], v[228:231], v[48:63]
ds_read_b64_tr_b16 v[132:133], v21 offset:27648
ds_read_b64_tr_b16 v[134:135], v21 offset:27904
v_mfma_f32_32x32x16_bf16 v[64:79], v[160:163], v[228:231], v[64:79]
ds_read_b64_tr_b16 v[136:137], v21 offset:25600
ds_read_b64_tr_b16 v[138:139], v21 offset:25856
s_waitcnt lgkmcnt(6)
v_mfma_f32_32x32x16_bf16 v[80:95], v[164:167], v[228:231], v[80:95]
ds_read_b64_tr_b16 v[140:141], v21 offset:28672
ds_read_b64_tr_b16 v[142:143], v21 offset:28928
v_mfma_f32_32x32x16_bf16 v[96:111], v[168:171], v[228:231], v[96:111]
ds_read_b64_tr_b16 v[144:145], v21 offset:26624
ds_read_b64_tr_b16 v[146:147], v21 offset:26880
v_mfma_f32_32x32x16_bf16 v[112:127], v[172:175], v[228:231], v[112:127]
ds_read_b64_tr_b16 v[148:149], v21 offset:29696
ds_read_b64_tr_b16 v[150:151], v21 offset:29952
s_waitcnt lgkmcnt(6)
v_mfma_f32_32x32x16_bf16 v[32:47], v[128:131], v[232:235], v[32:47]
ds_read_b64_tr_b16 v[152:153], v21 offset:30720
ds_read_b64_tr_b16 v[154:155], v21 offset:30976
v_mfma_f32_32x32x16_bf16 v[48:63], v[132:135], v[232:235], v[48:63]
ds_read_b64_tr_b16 v[156:157], v21 offset:33792
ds_read_b64_tr_b16 v[158:159], v21 offset:34048
v_mfma_f32_32x32x16_bf16 v[64:79], v[136:139], v[232:235], v[64:79]
ds_read_b64_tr_b16 v[160:161], v21 offset:31744
ds_read_b64_tr_b16 v[162:163], v21 offset:32000
s_waitcnt lgkmcnt(6)
v_mfma_f32_32x32x16_bf16 v[80:95], v[140:143], v[232:235], v[80:95]
ds_read_b64_tr_b16 v[164:165], v21 offset:34816
ds_read_b64_tr_b16 v[166:167], v21 offset:35072
v_mfma_f32_32x32x16_bf16 v[96:111], v[144:147], v[232:235], v[96:111]
ds_read_b64_tr_b16 v[168:169], v21 offset:32768
ds_read_b64_tr_b16 v[170:171], v21 offset:33024
v_mfma_f32_32x32x16_bf16 v[112:127], v[148:151], v[232:235], v[112:127]
ds_read_b64_tr_b16 v[172:173], v21 offset:35840
ds_read_b64_tr_b16 v[174:175], v21 offset:36096
s_waitcnt lgkmcnt(6)
v_mfma_f32_32x32x16_bf16 v[32:47], v[152:155], v[236:239], v[32:47]
ds_read_b64_tr_b16 v[128:129], v21 offset:36864
ds_read_b64_tr_b16 v[130:131], v21 offset:37120
v_mfma_f32_32x32x16_bf16 v[48:63], v[156:159], v[236:239], v[48:63]
ds_read_b64_tr_b16 v[132:133], v21 offset:39936
ds_read_b64_tr_b16 v[134:135], v21 offset:40192
v_mfma_f32_32x32x16_bf16 v[64:79], v[160:163], v[236:239], v[64:79]
ds_read_b64_tr_b16 v[136:137], v21 offset:37888
ds_read_b64_tr_b16 v[138:139], v21 offset:38144
s_waitcnt lgkmcnt(6)
v_mfma_f32_32x32x16_bf16 v[80:95], v[164:167], v[236:239], v[80:95]
ds_read_b64_tr_b16 v[140:141], v21 offset:40960
ds_read_b64_tr_b16 v[142:143], v21 offset:41216
v_mfma_f32_32x32x16_bf16 v[96:111], v[168:171], v[236:239], v[96:111]
ds_read_b64_tr_b16 v[144:145], v21 offset:38912
ds_read_b64_tr_b16 v[146:147], v21 offset:39168
v_mfma_f32_32x32x16_bf16 v[112:127], v[172:175], v[236:239], v[112:127]
ds_read_b64_tr_b16 v[148:149], v21 offset:41984
ds_read_b64_tr_b16 v[150:151], v21 offset:42240
s_waitcnt lgkmcnt(6)
v_mfma_f32_32x32x16_bf16 v[32:47], v[128:131], v[240:243], v[32:47]
ds_read_b64_tr_b16 v[152:153], v21 offset:43008
ds_read_b64_tr_b16 v[154:155], v21 offset:43264
v_mfma_f32_32x32x16_bf16 v[48:63], v[132:135], v[240:243], v[48:63]
ds_read_b64_tr_b16 v[156:157], v21 offset:46080
ds_read_b64_tr_b16 v[158:159], v21 offset:46336
v_mfma_f32_32x32x16_bf16 v[64:79], v[136:139], v[240:243], v[64:79]
ds_read_b64_tr_b16 v[160:161], v21 offset:44032
ds_read_b64_tr_b16 v[162:163], v21 offset:44288
s_waitcnt lgkmcnt(6)
v_mfma_f32_32x32x16_bf16 v[80:95], v[140:143], v[240:243], v[80:95]
ds_read_b64_tr_b16 v[164:165], v21 offset:47104
ds_read_b64_tr_b16 v[166:167], v21 offset:47360
v_mfma_f32_32x32x16_bf16 v[96:111], v[144:147], v[240:243], v[96:111]
ds_read_b64_tr_b16 v[168:169], v21 offset:45056
ds_read_b64_tr_b16 v[170:171], v21 offset:45312
v_mfma_f32_32x32x16_bf16 v[112:127], v[148:151], v[240:243], v[112:127]
ds_read_b64_tr_b16 v[172:173], v21 offset:48128
ds_read_b64_tr_b16 v[174:175], v21 offset:48384
s_waitcnt lgkmcnt(6)
v_mfma_f32_32x32x16_bf16 v[32:47], v[152:155], v[244:247], v[32:47]
v_mfma_f32_32x32x16_bf16 v[48:63], v[156:159], v[244:247], v[48:63]
v_mfma_f32_32x32x16_bf16 v[64:79], v[160:163], v[244:247], v[64:79]
s_waitcnt lgkmcnt(0)
v_mfma_f32_32x32x16_bf16 v[80:95], v[164:167], v[244:247], v[80:95]
v_mfma_f32_32x32x16_bf16 v[96:111], v[168:171], v[244:247], v[96:111]
v_mfma_f32_32x32x16_bf16 v[112:127], v[172:175], v[244:247], v[112:127]
v_mov_b32 v30, 0
buffer_load_dword v31, v30, s[32:35], 0 offen sc1
v_lshlrev_b32_e64 v2, 4, v0
s_mul_i32 s55, s50, 12288
s_add_u32 s55, s55, s68
s_nop 4
v_pk_mul_f32 v[184:185], v[32:33], s[76:77]
v_pk_mul_f32 v[186:187], v[34:35], s[76:77]
v_pk_mul_f32 v[188:189], v[36:37], s[76:77]
v_pk_mul_f32 v[190:191], v[38:39], s[76:77]
v_pk_mul_f32 v[192:193], v[40:41], s[76:77]
v_pk_mul_f32 v[194:195], v[42:43], s[76:77]
v_pk_mul_f32 v[196:197], v[44:45], s[76:77]
v_pk_mul_f32 v[198:199], v[46:47], s[76:77]
v_exp_f32 v184, v184
v_exp_f32 v185, v185
v_exp_f32 v186, v186
v_exp_f32 v187, v187
v_exp_f32 v188, v188
v_exp_f32 v189, v189
v_exp_f32 v190, v190
v_exp_f32 v191, v191
v_exp_f32 v192, v192
v_exp_f32 v193, v193
v_exp_f32 v194, v194
v_exp_f32 v195, v195
v_exp_f32 v196, v196
v_exp_f32 v197, v197
v_exp_f32 v198, v198
v_exp_f32 v199, v199
v_pk_mul_f32 v[32:33], v[32:33], v[48:49]
v_pk_mul_f32 v[34:35], v[34:35], v[50:51]
v_pk_mul_f32 v[36:37], v[36:37], v[52:53]
v_pk_mul_f32 v[38:39], v[38:39], v[54:55]
v_pk_mul_f32 v[40:41], v[40:41], v[56:57]
v_pk_mul_f32 v[42:43], v[42:43], v[58:59]
v_pk_mul_f32 v[44:45], v[44:45], v[60:61]
v_pk_mul_f32 v[46:47], v[46:47], v[62:63]
v_pk_add_f32 v[184:185], v[184:185], 1.0 op_sel_hi:[1,0]
v_pk_add_f32 v[186:187], v[186:187], 1.0 op_sel_hi:[1,0]
v_pk_add_f32 v[188:189], v[188:189], 1.0 op_sel_hi:[1,0]
v_pk_add_f32 v[190:191], v[190:191], 1.0 op_sel_hi:[1,0]
v_pk_add_f32 v[192:193], v[192:193], 1.0 op_sel_hi:[1,0]
v_pk_add_f32 v[194:195], v[194:195], 1.0 op_sel_hi:[1,0]
v_pk_add_f32 v[196:197], v[196:197], 1.0 op_sel_hi:[1,0]
v_pk_add_f32 v[198:199], v[198:199], 1.0 op_sel_hi:[1,0]
v_rcp_f32 v184, v184
v_rcp_f32 v185, v185
v_rcp_f32 v186, v186
v_rcp_f32 v187, v187
v_rcp_f32 v188, v188
v_rcp_f32 v189, v189
v_rcp_f32 v190, v190
v_rcp_f32 v191, v191
v_rcp_f32 v192, v192
v_rcp_f32 v193, v193
v_rcp_f32 v194, v194
v_rcp_f32 v195, v195
v_rcp_f32 v196, v196
v_rcp_f32 v197, v197
v_rcp_f32 v198, v198
v_rcp_f32 v199, v199
s_nop 0
v_pk_mul_f32 v[32:33], v[32:33], v[184:185]
v_pk_mul_f32 v[34:35], v[34:35], v[186:187]
v_pk_mul_f32 v[36:37], v[36:37], v[188:189]
v_pk_mul_f32 v[38:39], v[38:39], v[190:191]
v_pk_mul_f32 v[40:41], v[40:41], v[192:193]
v_pk_mul_f32 v[42:43], v[42:43], v[194:195]
v_pk_mul_f32 v[44:45], v[44:45], v[196:197]
v_pk_mul_f32 v[46:47], v[46:47], v[198:199]
v_cvt_pk_bf16_f32 v200, v32, v33
v_cvt_pk_bf16_f32 v201, v34, v35
v_cvt_pk_bf16_f32 v202, v36, v37
v_cvt_pk_bf16_f32 v203, v38, v39
v_cvt_pk_bf16_f32 v204, v40, v41
v_cvt_pk_bf16_f32 v205, v42, v43
v_cvt_pk_bf16_f32 v206, v44, v45
v_cvt_pk_bf16_f32 v207, v46, v47
buffer_store_dwordx4 v[200:203], v2, s[36:39], s55 offen sc1
buffer_store_dwordx4 v[204:207], v2, s[36:39], s55 offen offset:2048 sc1
s_add_u32 s55, s55, 4096
v_pk_mul_f32 v[184:185], v[64:65], s[76:77]
v_pk_mul_f32 v[186:187], v[66:67], s[76:77]
v_pk_mul_f32 v[188:189], v[68:69], s[76:77]
v_pk_mul_f32 v[190:191], v[70:71], s[76:77]
v_pk_mul_f32 v[192:193], v[72:73], s[76:77]
v_pk_mul_f32 v[194:195], v[74:75], s[76:77]
v_pk_mul_f32 v[196:197], v[76:77], s[76:77]
v_pk_mul_f32 v[198:199], v[78:79], s[76:77]
v_exp_f32 v184, v184
v_exp_f32 v185, v185
v_exp_f32 v186, v186
v_exp_f32 v187, v187
v_exp_f32 v188, v188
v_exp_f32 v189, v189
v_exp_f32 v190, v190
v_exp_f32 v191, v191
v_exp_f32 v192, v192
v_exp_f32 v193, v193
v_exp_f32 v194, v194
v_exp_f32 v195, v195
v_exp_f32 v196, v196
v_exp_f32 v197, v197
v_exp_f32 v198, v198
v_exp_f32_e64 v199, v199
v_pk_mul_f32 v[64:65], v[64:65], v[80:81]
v_pk_mul_f32 v[66:67], v[66:67], v[82:83]
v_pk_mul_f32 v[68:69], v[68:69], v[84:85]
v_pk_mul_f32 v[70:71], v[70:71], v[86:87]
v_pk_mul_f32 v[72:73], v[72:73], v[88:89]
v_pk_mul_f32 v[74:75], v[74:75], v[90:91]
v_pk_mul_f32 v[76:77], v[76:77], v[92:93]
v_pk_mul_f32 v[78:79], v[78:79], v[94:95]
v_pk_add_f32 v[184:185], v[184:185], 1.0 op_sel_hi:[1,0]
v_pk_add_f32 v[186:187], v[186:187], 1.0 op_sel_hi:[1,0]
v_pk_add_f32 v[188:189], v[188:189], 1.0 op_sel_hi:[1,0]
v_pk_add_f32 v[190:191], v[190:191], 1.0 op_sel_hi:[1,0]
v_pk_add_f32 v[192:193], v[192:193], 1.0 op_sel_hi:[1,0]
v_pk_add_f32 v[194:195], v[194:195], 1.0 op_sel_hi:[1,0]
v_pk_add_f32 v[196:197], v[196:197], 1.0 op_sel_hi:[1,0]
v_pk_add_f32 v[198:199], v[198:199], 1.0 op_sel_hi:[1,0]
v_rcp_f32 v184, v184
v_rcp_f32 v185, v185
v_rcp_f32 v186, v186
v_rcp_f32 v187, v187
v_rcp_f32 v188, v188
v_rcp_f32 v189, v189
v_rcp_f32 v190, v190
v_rcp_f32 v191, v191
v_rcp_f32 v192, v192
v_rcp_f32 v193, v193
v_rcp_f32 v194, v194
v_rcp_f32 v195, v195
v_rcp_f32 v196, v196
v_rcp_f32 v197, v197
v_rcp_f32 v198, v198
v_rcp_f32 v199, v199
s_nop 0
v_pk_mul_f32 v[64:65], v[64:65], v[184:185]
v_pk_mul_f32 v[66:67], v[66:67], v[186:187]
v_pk_mul_f32 v[68:69], v[68:69], v[188:189]
v_pk_mul_f32 v[70:71], v[70:71], v[190:191]
v_pk_mul_f32 v[72:73], v[72:73], v[192:193]
v_pk_mul_f32 v[74:75], v[74:75], v[194:195]
v_pk_mul_f32 v[76:77], v[76:77], v[196:197]
v_pk_mul_f32 v[78:79], v[78:79], v[198:199]
v_cvt_pk_bf16_f32 v208, v64, v65
v_cvt_pk_bf16_f32 v209, v66, v67
v_cvt_pk_bf16_f32 v210, v68, v69
v_cvt_pk_bf16_f32 v211, v70, v71
v_cvt_pk_bf16_f32 v212, v72, v73
v_cvt_pk_bf16_f32 v213, v74, v75
v_cvt_pk_bf16_f32 v214, v76, v77
v_cvt_pk_bf16_f32 v215, v78, v79
buffer_store_dwordx4 v[208:211], v2, s[36:39], s55 offen sc1
buffer_store_dwordx4 v[212:215], v2, s[36:39], s55 offen offset:2048 sc1
s_add_u32 s55, s55, 4096
v_pk_mul_f32 v[184:185], v[96:97], s[76:77]
v_pk_mul_f32 v[186:187], v[98:99], s[76:77]
v_pk_mul_f32 v[188:189], v[100:101], s[76:77]
v_pk_mul_f32 v[190:191], v[102:103], s[76:77]
v_pk_mul_f32 v[192:193], v[104:105], s[76:77]
v_pk_mul_f32 v[194:195], v[106:107], s[76:77]
v_pk_mul_f32 v[196:197], v[108:109], s[76:77]
v_pk_mul_f32 v[198:199], v[110:111], s[76:77]
v_exp_f32 v184, v184
v_exp_f32 v185, v185
v_exp_f32 v186, v186
v_exp_f32 v187, v187
v_exp_f32 v188, v188
v_exp_f32 v189, v189
v_exp_f32 v190, v190
v_exp_f32 v191, v191
v_exp_f32 v192, v192
v_exp_f32 v193, v193
v_exp_f32 v194, v194
v_exp_f32 v195, v195
v_exp_f32 v196, v196
v_exp_f32 v197, v197
v_exp_f32 v198, v198
v_exp_f32_e64 v199, v199
v_pk_mul_f32 v[96:97], v[96:97], v[112:113]
v_pk_mul_f32 v[98:99], v[98:99], v[114:115]
v_pk_mul_f32 v[100:101], v[100:101], v[116:117]
v_pk_mul_f32 v[102:103], v[102:103], v[118:119]
v_pk_mul_f32 v[104:105], v[104:105], v[120:121]
v_pk_mul_f32 v[106:107], v[106:107], v[122:123]
v_pk_mul_f32 v[108:109], v[108:109], v[124:125]
v_pk_mul_f32 v[110:111], v[110:111], v[126:127]
v_pk_add_f32 v[184:185], v[184:185], 1.0 op_sel_hi:[1,0]
v_pk_add_f32 v[186:187], v[186:187], 1.0 op_sel_hi:[1,0]
v_pk_add_f32 v[188:189], v[188:189], 1.0 op_sel_hi:[1,0]
v_pk_add_f32 v[190:191], v[190:191], 1.0 op_sel_hi:[1,0]
v_pk_add_f32 v[192:193], v[192:193], 1.0 op_sel_hi:[1,0]
v_pk_add_f32 v[194:195], v[194:195], 1.0 op_sel_hi:[1,0]
v_pk_add_f32 v[196:197], v[196:197], 1.0 op_sel_hi:[1,0]
v_pk_add_f32 v[198:199], v[198:199], 1.0 op_sel_hi:[1,0]
v_rcp_f32 v184, v184
v_rcp_f32 v185, v185
v_rcp_f32 v186, v186
v_rcp_f32 v187, v187
v_rcp_f32 v188, v188
v_rcp_f32 v189, v189
v_rcp_f32 v190, v190
v_rcp_f32 v191, v191
v_rcp_f32 v192, v192
v_rcp_f32 v193, v193
v_rcp_f32 v194, v194
v_rcp_f32 v195, v195
v_rcp_f32 v196, v196
v_rcp_f32 v197, v197
v_rcp_f32 v198, v198
v_rcp_f32 v199, v199
s_nop 0
v_pk_mul_f32 v[96:97], v[96:97], v[184:185]
v_pk_mul_f32 v[98:99], v[98:99], v[186:187]
v_pk_mul_f32 v[100:101], v[100:101], v[188:189]
v_pk_mul_f32 v[102:103], v[102:103], v[190:191]
v_pk_mul_f32 v[104:105], v[104:105], v[192:193]
v_pk_mul_f32 v[106:107], v[106:107], v[194:195]
v_pk_mul_f32 v[108:109], v[108:109], v[196:197]
v_pk_mul_f32 v[110:111], v[110:111], v[198:199]
v_cvt_pk_bf16_f32 v216, v96, v97
v_cvt_pk_bf16_f32 v217, v98, v99
v_cvt_pk_bf16_f32 v218, v100, v101
v_cvt_pk_bf16_f32 v219, v102, v103
v_cvt_pk_bf16_f32 v220, v104, v105
v_cvt_pk_bf16_f32 v221, v106, v107
v_cvt_pk_bf16_f32 v222, v108, v109
v_cvt_pk_bf16_f32 v223, v110, v111
buffer_store_dwordx4 v[216:219], v2, s[36:39], s55 offen sc1
buffer_store_dwordx4 v[220:223], v2, s[36:39], s55 offen offset:2048 sc1
v_mov_b32 v15, 14336
v_mov_b32 v4, 1
s_mov_b64 exec, 1
ds_add_u32 v15, v4 offset:12
s_mov_b64 exec, -1
s_waitcnt vmcnt(0)
v_mov_b32 v15, 14336
v_mov_b32 v4, 1
s_mov_b64 exec, 1
ds_add_rtn_u32 v4, v15, v4 offset:4
s_mov_b64 exec, -1
s_waitcnt lgkmcnt(0)
v_readfirstlane_b32 s53, v4
s_and_b32 s53, s53, 3
s_cmp_lg_u32 s53, 3
s_cbranch_scc1 LsFskip
s_mov_b32 s56, 0
LsFpoll:
v_readfirstlane_b32 s53, v31
s_cmp_lg_u32 s53, 0
s_cbranch_scc1 LsFok
s_add_u32 s56, s56, 1
s_cmp_ge_u32 s56, 0x80000
s_cbranch_scc1 LsFok
s_sleep 2
buffer_load_dword v31, v30, s[32:35], 0 offen sc1
s_waitcnt vmcnt(0)
s_branch LsFpoll
LsFok:
v_lshlrev_b32 v29, 7, v0
s_mov_b64 exec, 3
buffer_store_dword v31, v29, s[36:39], s73 offen sc1
s_mov_b64 exec, -1
LsFskip:
s_branch LC2
LCS:
v_and_b32 v12, 31, v0
v_lshrrev_b32 v7, 5, v0
v_bfe_u32 v13, v0, 1, 3
v_xor_b32 v13, v13, v7
v_lshlrev_b32 v12, 7, v12
v_xor_b32_e64 v14, 0, v13
v_lshl_add_u32 v8, v14, 4, v12
v_xor_b32_e64 v14, 2, v13
v_lshl_add_u32 v9, v14, 4, v12
v_xor_b32_e64 v14, 4, v13
v_lshl_add_u32 v10, v14, 4, v12
v_xor_b32_e64 v14, 6, v13
v_lshl_add_u32 v11, v14, 4, v12
s_xor_b32 s53, s2, 255
s_or_b32 s53, s53, s48
s_cmp_lg_u32 s53, 0
s_cbranch_scc1 Lnoinit
v_mov_b32 v32, 0
v_mov_b32 v33, 0
v_mov_b32 v34, 0
v_mov_b32 v35, 0
v_lshlrev_b32 v36, 4, v0
s_mov_b32 s54, 8396800
s_mov_b32 s55, 8400896
buffer_store_dwordx4 v[32:35], v36, s[36:39], s54 offen offset:0 sc1
buffer_store_dwordx4 v[32:35], v36, s[36:39], s54 offen offset:1024 sc1
buffer_store_dwordx4 v[32:35], v36, s[36:39], s54 offen offset:2048 sc1
buffer_store_dwordx4 v[32:35], v36, s[36:39], s54 offen offset:3072 sc1
buffer_store_dwordx4 v[32:35], v36, s[36:39], s55 offen offset:0 sc1
buffer_store_dwordx4 v[32:35], v36, s[36:39], s55 offen offset:1024 sc1
buffer_store_dwordx4 v[32:35], v36, s[36:39], s55 offen offset:2048 sc1
buffer_store_dwordx4 v[32:35], v36, s[36:39], s55 offen offset:3072 sc1
s_nop 1
Lnoinit:
v_and_b32 v5, 31, v0
v_cvt_f32_u32_e64 v5, v5
v_mul_f32 v5, 0x3d000000, v5
v_lshrrev_b32 v7, 5, v0
v_lshlrev_b32 v7, 2, v7
v_cvt_f32_u32 v7, v7
v_mul_f32 v7, v7, v5
v_mov_b32_e64 v4, 0.0
v_fma_f32 v4, v4, v5, v7
v_fract_f32 v4, v4
v_cos_f32 v48, v4
v_sin_f32 v56, v4
v_mov_b32 v4, 1.0
v_fma_f32 v4, v4, v5, v7
v_fract_f32 v4, v4
v_cos_f32 v49, v4
v_sin_f32 v57, v4
v_mov_b32 v4, 2.0
v_fma_f32 v4, v4, v5, v7
v_fract_f32 v4, v4
v_cos_f32 v50, v4
v_sin_f32_e64 v58, v4
v_mov_b32 v4, 3.0
v_fma_f32 v4, v4, v5, v7
v_fract_f32 v4, v4
v_cos_f32 v51, v4
v_sin_f32_e64 v59, v4
v_mov_b32 v4, 8.0
v_fma_f32 v4, v4, v5, v7
v_fract_f32 v4, v4
v_cos_f32 v52, v4
v_sin_f32_e64 v60, v4
v_mov_b32 v4, 9.0
v_fma_f32 v4, v4, v5, v7
v_fract_f32 v4, v4
v_cos_f32 v53, v4
v_sin_f32_e64 v61, v4
v_mov_b32 v4, 10.0
v_fma_f32 v4, v4, v5, v7
v_fract_f32 v4, v4
v_cos_f32 v54, v4
v_sin_f32_e64 v62, v4
v_mov_b32 v4, 11.0
v_fma_f32 v4, v4, v5, v7
v_fract_f32 v4, v4
v_cos_f32 v55, v4
v_sin_f32 v63, v4
s_nop 0
v_cvt_pk_bf16_f32 v24, v48, v49
v_cvt_pk_bf16_f32 v32, v56, v57
v_cvt_pk_bf16_f32 v40, -v56, -v57
v_cvt_pk_bf16_f32 v25, v50, v51
v_cvt_pk_bf16_f32 v33, v58, v59
v_cvt_pk_bf16_f32 v41, -v58, -v59
v_cvt_pk_bf16_f32 v26, v52, v53
v_cvt_pk_bf16_f32 v34, v60, v61
v_cvt_pk_bf16_f32 v42, -v60, -v61
v_cvt_pk_bf16_f32 v27, v54, v55
v_cvt_pk_bf16_f32 v35, v62, v63
v_cvt_pk_bf16_f32 v43, -v62, -v63
v_mov_b32 v4, 16.0
v_fma_f32 v4, v4, v5, v7
v_fract_f32 v4, v4
v_cos_f32 v48, v4
v_sin_f32_e64 v56, v4
v_mov_b32 v4, 17.0
v_fma_f32 v4, v4, v5, v7
v_fract_f32 v4, v4
v_cos_f32 v49, v4
v_sin_f32_e64 v57, v4
v_mov_b32 v4, 18.0
v_fma_f32 v4, v4, v5, v7
v_fract_f32 v4, v4
v_cos_f32 v50, v4
v_sin_f32_e64 v58, v4
v_mov_b32 v4, 19.0
v_fma_f32 v4, v4, v5, v7
v_fract_f32 v4, v4
v_cos_f32 v51, v4
v_sin_f32_e64 v59, v4
v_mov_b32 v4, 24.0
v_fma_f32 v4, v4, v5, v7
v_fract_f32 v4, v4
v_cos_f32 v52, v4
v_sin_f32_e64 v60, v4
v_mov_b32 v4, 25.0
v_fma_f32 v4, v4, v5, v7
v_fract_f32 v4, v4
v_cos_f32 v53, v4
v_sin_f32_e64 v61, v4
v_mov_b32 v4, 26.0
v_fma_f32 v4, v4, v5, v7
v_fract_f32 v4, v4
v_cos_f32 v54, v4
v_sin_f32_e64 v62, v4
v_mov_b32 v4, 27.0
v_fma_f32 v4, v4, v5, v7
v_fract_f32 v4, v4
v_cos_f32 v55, v4
v_sin_f32 v63, v4
s_nop 0
v_cvt_pk_bf16_f32 v28, v48, v49
v_cvt_pk_bf16_f32 v36, v56, v57
v_cvt_pk_bf16_f32 v44, -v56, -v57
v_cvt_pk_bf16_f32 v29, v50, v51
v_cvt_pk_bf16_f32 v37, v58, v59
v_cvt_pk_bf16_f32 v45, -v58, -v59
v_cvt_pk_bf16_f32 v30, v52, v53
v_cvt_pk_bf16_f32 v38, v60, v61
v_cvt_pk_bf16_f32 v46, -v60, -v61
v_cvt_pk_bf16_f32 v31, v54, v55
v_cvt_pk_bf16_f32 v39, v62, v63
v_cvt_pk_bf16_f32 v47, -v62, -v63
s_lshl_b32 s53, s48, 6
s_add_u32 s53, s53, s59
s_add_u32 s53, s53, 256
v_and_b32_e64 v5, 31, v0
v_lshl_add_u32 v5, v5, 1, s53
v_cvt_f32_u32_e64 v5, v5
v_mul_f32 v5, 0x3b000000, v5
v_lshrrev_b32 v7, 5, v0
v_lshlrev_b32 v7, 3, v7
v_lshlrev_b32 v12, 4, v0
v_add_u32 v12, s46, v12
v_and_b32 v13, 1, v0
v_sub_u32 v13, 0, v13
v_and_b32 v13, 0x80008000, v13
s_mul_i32 s53, s59, 0x80008000
v_xor_b32 v14, s53, v13
s_lshl_b32 s53, s59, 10
v_add_u32_e64 v15, s53, v12
v_xor_b32 v16, 1024, v15
s_add_u32 s53, s51, 0
s_and_b32 s53, s53, 7
s_lshl_b32 s53, s53, 6
v_add_u32 v4, s53, v7
v_cvt_f32_u32 v4, v4
v_mul_f32 v4, v4, v5
v_fmamk_f32 v128, v5, 0x0, v4
v_fmamk_f32 v129, v5, 0x3f800000, v4
v_fmamk_f32 v130, v5, 0x40000000, v4
v_fmamk_f32 v131, v5, 0x40400000, v4
v_fmamk_f32 v132, v5, 0x40800000, v4
v_fmamk_f32 v133, v5, 0x40a00000, v4
v_fmamk_f32 v134, v5, 0x40c00000, v4
v_fmamk_f32 v135, v5, 0x40e00000, v4
v_fract_f32 v128, v128
v_fract_f32 v129, v129
v_fract_f32 v130, v130
v_fract_f32 v131, v131
v_fract_f32 v132, v132
v_fract_f32 v133, v133
v_fract_f32 v134, v134
v_fract_f32 v135, v135
v_cos_f32 v136, v128
v_sin_f32 v144, v128
v_cos_f32 v137, v129
v_sin_f32 v145, v129
v_cos_f32 v138, v130
v_sin_f32 v146, v130
v_cos_f32 v139, v131
v_sin_f32 v147, v131
v_cos_f32 v140, v132
v_sin_f32 v148, v132
v_cos_f32 v141, v133
v_sin_f32 v149, v133
v_cos_f32 v142, v134
v_sin_f32 v150, v134
v_cos_f32 v143, v135
v_sin_f32 v151, v135
v_cvt_pk_bf16_f32 v64, v136, v137
v_cvt_pk_bf16_f32 v65, v138, v139
v_cvt_pk_bf16_f32 v66, v140, v141
v_cvt_pk_bf16_f32 v67, v142, v143
v_cvt_pk_bf16_f32 v68, -v144, -v145
v_cvt_pk_bf16_f32 v69, -v146, -v147
v_cvt_pk_bf16_f32 v70, -v148, -v149
v_cvt_pk_bf16_f32 v71, -v150, -v151
v_xor_b32 v152, v14, v64
v_xor_b32 v153, v14, v65
v_xor_b32 v154, v14, v66
v_xor_b32 v155, v14, v67
v_xor_b32 v156, v13, v68
v_xor_b32 v157, v13, v69
v_xor_b32 v158, v13, v70
v_xor_b32 v159, v13, v71
ds_write_b128 v15, v[152:155] offset:0
ds_write_b128 v16, v[156:159] offset:0
v_fmamk_f32 v128, v5, 0x41800000, v4
v_fmamk_f32 v129, v5, 0x41880000, v4
v_fmamk_f32 v130, v5, 0x41900000, v4
v_fmamk_f32 v131, v5, 0x41980000, v4
v_fmamk_f32 v132, v5, 0x41a00000, v4
v_fmamk_f32 v133, v5, 0x41a80000, v4
v_fmamk_f32 v134, v5, 0x41b00000, v4
v_fmamk_f32 v135, v5, 0x41b80000, v4
v_fract_f32 v128, v128
v_fract_f32 v129, v129
v_fract_f32 v130, v130
v_fract_f32 v131, v131
v_fract_f32 v132, v132
v_fract_f32 v133, v133
v_fract_f32 v134, v134
v_fract_f32 v135, v135
v_cos_f32 v136, v128
v_sin_f32 v144, v128
v_cos_f32 v137, v129
v_sin_f32 v145, v129
v_cos_f32 v138, v130
v_sin_f32 v146, v130
v_cos_f32 v139, v131
v_sin_f32 v147, v131
v_cos_f32 v140, v132
v_sin_f32 v148, v132
v_cos_f32 v141, v133
v_sin_f32 v149, v133
v_cos_f32 v142, v134
v_sin_f32 v150, v134
v_cos_f32 v143, v135
v_sin_f32 v151, v135
v_cvt_pk_bf16_f32 v72, v136, v137
v_cvt_pk_bf16_f32 v73, v138, v139
v_cvt_pk_bf16_f32 v74, v140, v141
v_cvt_pk_bf16_f32 v75, v142, v143
v_cvt_pk_bf16_f32 v76, -v144, -v145
v_cvt_pk_bf16_f32 v77, -v146, -v147
v_cvt_pk_bf16_f32 v78, -v148, -v149
v_cvt_pk_bf16_f32 v79, -v150, -v151
v_xor_b32 v160, v14, v72
v_xor_b32 v161, v14, v73
v_xor_b32 v162, v14, v74
v_xor_b32 v163, v14, v75
v_xor_b32 v164, v13, v76
v_xor_b32 v165, v13, v77
v_xor_b32 v166, v13, v78
v_xor_b32 v167, v13, v79
ds_write_b128 v15, v[160:163] offset:2048
ds_write_b128 v16, v[164:167] offset:2048
v_fmamk_f32 v128, v5, 0x42000000, v4
v_fmamk_f32 v129, v5, 0x42040000, v4
v_fmamk_f32 v130, v5, 0x42080000, v4
v_fmamk_f32 v131, v5, 0x420c0000, v4
v_fmamk_f32 v132, v5, 0x42100000, v4
v_fmamk_f32 v133, v5, 0x42140000, v4
v_fmamk_f32 v134, v5, 0x42180000, v4
v_fmamk_f32 v135, v5, 0x421c0000, v4
v_fract_f32 v128, v128
v_fract_f32 v129, v129
v_fract_f32 v130, v130
v_fract_f32 v131, v131
v_fract_f32 v132, v132
v_fract_f32 v133, v133
v_fract_f32 v134, v134
v_fract_f32 v135, v135
v_cos_f32 v136, v128
v_sin_f32 v144, v128
v_cos_f32 v137, v129
v_sin_f32 v145, v129
v_cos_f32 v138, v130
v_sin_f32 v146, v130
v_cos_f32 v139, v131
v_sin_f32 v147, v131
v_cos_f32 v140, v132
v_sin_f32 v148, v132
v_cos_f32 v141, v133
v_sin_f32 v149, v133
v_cos_f32 v142, v134
v_sin_f32 v150, v134
v_cos_f32 v143, v135
v_sin_f32 v151, v135
v_cvt_pk_bf16_f32 v80, v136, v137
v_cvt_pk_bf16_f32 v81, v138, v139
v_cvt_pk_bf16_f32 v82, v140, v141
v_cvt_pk_bf16_f32 v83, v142, v143
v_cvt_pk_bf16_f32 v84, -v144, -v145
v_cvt_pk_bf16_f32 v85, -v146, -v147
v_cvt_pk_bf16_f32 v86, -v148, -v149
v_cvt_pk_bf16_f32 v87, -v150, -v151
v_xor_b32 v152, v14, v80
v_xor_b32 v153, v14, v81
v_xor_b32 v154, v14, v82
v_xor_b32 v155, v14, v83
v_xor_b32 v156, v13, v84
v_xor_b32 v157, v13, v85
v_xor_b32 v158, v13, v86
v_xor_b32 v159, v13, v87
ds_write_b128 v15, v[152:155] offset:4096
ds_write_b128 v16, v[156:159] offset:4096
v_fmamk_f32 v128, v5, 0x42400000, v4
v_fmamk_f32 v129, v5, 0x42440000, v4
v_fmamk_f32 v130, v5, 0x42480000, v4
v_fmamk_f32 v131, v5, 0x424c0000, v4
v_fmamk_f32 v132, v5, 0x42500000, v4
v_fmamk_f32 v133, v5, 0x42540000, v4
v_fmamk_f32 v134, v5, 0x42580000, v4
v_fmamk_f32 v135, v5, 0x425c0000, v4
v_fract_f32 v128, v128
v_fract_f32 v129, v129
v_fract_f32 v130, v130
v_fract_f32 v131, v131
v_fract_f32 v132, v132
v_fract_f32 v133, v133
v_fract_f32 v134, v134
v_fract_f32 v135, v135
v_cos_f32 v136, v128
v_sin_f32 v144, v128
v_cos_f32 v137, v129
v_sin_f32 v145, v129
v_cos_f32 v138, v130
v_sin_f32 v146, v130
v_cos_f32 v139, v131
v_sin_f32 v147, v131
v_cos_f32 v140, v132
v_sin_f32 v148, v132
v_cos_f32 v141, v133
v_sin_f32 v149, v133
v_cos_f32 v142, v134
v_sin_f32 v150, v134
v_cos_f32 v143, v135
v_sin_f32 v151, v135
v_cvt_pk_bf16_f32 v88, v136, v137
v_cvt_pk_bf16_f32 v89, v138, v139
v_cvt_pk_bf16_f32 v90, v140, v141
v_cvt_pk_bf16_f32 v91, v142, v143
v_cvt_pk_bf16_f32 v92, -v144, -v145
v_cvt_pk_bf16_f32 v93, -v146, -v147
v_cvt_pk_bf16_f32 v94, -v148, -v149
v_cvt_pk_bf16_f32 v95, -v150, -v151
v_xor_b32 v160, v14, v88
v_xor_b32 v161, v14, v89
v_xor_b32 v162, v14, v90
v_xor_b32 v163, v14, v91
v_xor_b32 v164, v13, v92
v_xor_b32 v165, v13, v93
v_xor_b32 v166, v13, v94
v_xor_b32 v167, v13, v95
ds_write_b128 v15, v[160:163] offset:6144
ds_write_b128 v16, v[164:167] offset:6144
s_add_u32 s53, s51, 1
s_and_b32 s53, s53, 7
s_lshl_b32 s53, s53, 6
v_add_u32 v4, s53, v7
v_cvt_f32_u32 v4, v4
v_mul_f32 v4, v4, v5
v_fmamk_f32 v128, v5, 0x0, v4
v_fmamk_f32 v129, v5, 0x3f800000, v4
v_fmamk_f32 v130, v5, 0x40000000, v4
v_fmamk_f32 v131, v5, 0x40400000, v4
v_fmamk_f32 v132, v5, 0x40800000, v4
v_fmamk_f32 v133, v5, 0x40a00000, v4
v_fmamk_f32 v134, v5, 0x40c00000, v4
v_fmamk_f32 v135, v5, 0x40e00000, v4
v_fract_f32 v128, v128
v_fract_f32 v129, v129
v_fract_f32 v130, v130
v_fract_f32 v131, v131
v_fract_f32 v132, v132
v_fract_f32 v133, v133
v_fract_f32 v134, v134
v_fract_f32 v135, v135
v_cos_f32 v136, v128
v_sin_f32 v144, v128
v_cos_f32 v137, v129
v_sin_f32 v145, v129
v_cos_f32 v138, v130
v_sin_f32 v146, v130
v_cos_f32 v139, v131
v_sin_f32 v147, v131
v_cos_f32 v140, v132
v_sin_f32 v148, v132
v_cos_f32 v141, v133
v_sin_f32 v149, v133
v_cos_f32 v142, v134
v_sin_f32 v150, v134
v_cos_f32 v143, v135
v_sin_f32 v151, v135
v_cvt_pk_bf16_f32 v96, v136, v137
v_cvt_pk_bf16_f32 v97, v138, v139
v_cvt_pk_bf16_f32 v98, v140, v141
v_cvt_pk_bf16_f32 v99, v142, v143
v_cvt_pk_bf16_f32 v100, -v144, -v145
v_cvt_pk_bf16_f32 v101, -v146, -v147
v_cvt_pk_bf16_f32 v102, -v148, -v149
v_cvt_pk_bf16_f32 v103, -v150, -v151
v_xor_b32 v152, v14, v96
v_xor_b32 v153, v14, v97
v_xor_b32 v154, v14, v98
v_xor_b32 v155, v14, v99
v_xor_b32 v156, v13, v100
v_xor_b32 v157, v13, v101
v_xor_b32 v158, v13, v102
v_xor_b32 v159, v13, v103
ds_write_b128 v15, v[152:155] offset:8192
ds_write_b128 v16, v[156:159] offset:8192
v_fmamk_f32 v128, v5, 0x41800000, v4
v_fmamk_f32 v129, v5, 0x41880000, v4
v_fmamk_f32 v130, v5, 0x41900000, v4
v_fmamk_f32 v131, v5, 0x41980000, v4
v_fmamk_f32 v132, v5, 0x41a00000, v4
v_fmamk_f32 v133, v5, 0x41a80000, v4
v_fmamk_f32 v134, v5, 0x41b00000, v4
v_fmamk_f32 v135, v5, 0x41b80000, v4
v_fract_f32 v128, v128
v_fract_f32 v129, v129
v_fract_f32 v130, v130
v_fract_f32 v131, v131
v_fract_f32 v132, v132
v_fract_f32 v133, v133
v_fract_f32 v134, v134
v_fract_f32 v135, v135
v_cos_f32 v136, v128
v_sin_f32 v144, v128
v_cos_f32 v137, v129
v_sin_f32 v145, v129
v_cos_f32 v138, v130
v_sin_f32 v146, v130
v_cos_f32 v139, v131
v_sin_f32 v147, v131
v_cos_f32 v140, v132
v_sin_f32 v148, v132
v_cos_f32 v141, v133
v_sin_f32 v149, v133
v_cos_f32 v142, v134
v_sin_f32 v150, v134
v_cos_f32 v143, v135
v_sin_f32 v151, v135
v_cvt_pk_bf16_f32 v104, v136, v137
v_cvt_pk_bf16_f32 v105, v138, v139
v_cvt_pk_bf16_f32 v106, v140, v141
v_cvt_pk_bf16_f32 v107, v142, v143
v_cvt_pk_bf16_f32 v108, -v144, -v145
v_cvt_pk_bf16_f32 v109, -v146, -v147
v_cvt_pk_bf16_f32 v110, -v148, -v149
v_cvt_pk_bf16_f32 v111, -v150, -v151
v_xor_b32 v160, v14, v104
v_xor_b32 v161, v14, v105
v_xor_b32 v162, v14, v106
v_xor_b32 v163, v14, v107
v_xor_b32 v164, v13, v108
v_xor_b32 v165, v13, v109
v_xor_b32 v166, v13, v110
v_xor_b32 v167, v13, v111
ds_write_b128 v15, v[160:163] offset:10240
ds_write_b128 v16, v[164:167] offset:10240
v_fmamk_f32 v128, v5, 0x42000000, v4
v_fmamk_f32 v129, v5, 0x42040000, v4
v_fmamk_f32 v130, v5, 0x42080000, v4
v_fmamk_f32 v131, v5, 0x420c0000, v4
v_fmamk_f32 v132, v5, 0x42100000, v4
v_fmamk_f32 v133, v5, 0x42140000, v4
v_fmamk_f32 v134, v5, 0x42180000, v4
v_fmamk_f32 v135, v5, 0x421c0000, v4
v_fract_f32 v128, v128
v_fract_f32 v129, v129
v_fract_f32 v130, v130
v_fract_f32 v131, v131
v_fract_f32 v132, v132
v_fract_f32 v133, v133
v_fract_f32 v134, v134
v_fract_f32 v135, v135
v_cos_f32 v136, v128
v_sin_f32 v144, v128
v_cos_f32 v137, v129
v_sin_f32 v145, v129
v_cos_f32 v138, v130
v_sin_f32 v146, v130
v_cos_f32 v139, v131
v_sin_f32 v147, v131
v_cos_f32 v140, v132
v_sin_f32 v148, v132
v_cos_f32 v141, v133
v_sin_f32 v149, v133
v_cos_f32 v142, v134
v_sin_f32 v150, v134
v_cos_f32 v143, v135
v_sin_f32 v151, v135
v_cvt_pk_bf16_f32 v112, v136, v137
v_cvt_pk_bf16_f32 v113, v138, v139
v_cvt_pk_bf16_f32 v114, v140, v141
v_cvt_pk_bf16_f32 v115, v142, v143
v_cvt_pk_bf16_f32 v116, -v144, -v145
v_cvt_pk_bf16_f32 v117, -v146, -v147
v_cvt_pk_bf16_f32 v118, -v148, -v149
v_cvt_pk_bf16_f32 v119, -v150, -v151
v_xor_b32 v152, v14, v112
v_xor_b32 v153, v14, v113
v_xor_b32 v154, v14, v114
v_xor_b32 v155, v14, v115
v_xor_b32 v156, v13, v116
v_xor_b32 v157, v13, v117
v_xor_b32 v158, v13, v118
v_xor_b32 v159, v13, v119
ds_write_b128 v15, v[152:155] offset:12288
ds_write_b128 v16, v[156:159] offset:12288
v_fmamk_f32 v128, v5, 0x42400000, v4
v_fmamk_f32 v129, v5, 0x42440000, v4
v_fmamk_f32 v130, v5, 0x42480000, v4
v_fmamk_f32 v131, v5, 0x424c0000, v4
v_fmamk_f32 v132, v5, 0x42500000, v4
v_fmamk_f32 v133, v5, 0x42540000, v4
v_fmamk_f32 v134, v5, 0x42580000, v4
v_fmamk_f32 v135, v5, 0x425c0000, v4
v_fract_f32 v128, v128
v_fract_f32 v129, v129
v_fract_f32 v130, v130
v_fract_f32 v131, v131
v_fract_f32 v132, v132
v_fract_f32 v133, v133
v_fract_f32 v134, v134
v_fract_f32 v135, v135
v_cos_f32 v136, v128
v_sin_f32 v144, v128
v_cos_f32 v137, v129
v_sin_f32 v145, v129
v_cos_f32 v138, v130
v_sin_f32 v146, v130
v_cos_f32 v139, v131
v_sin_f32 v147, v131
v_cos_f32 v140, v132
v_sin_f32 v148, v132
v_cos_f32 v141, v133
v_sin_f32 v149, v133
v_cos_f32 v142, v134
v_sin_f32 v150, v134
v_cos_f32 v143, v135
v_sin_f32 v151, v135
v_cvt_pk_bf16_f32 v120, v136, v137
v_cvt_pk_bf16_f32 v121, v138, v139
v_cvt_pk_bf16_f32 v122, v140, v141
v_cvt_pk_bf16_f32 v123, v142, v143
v_cvt_pk_bf16_f32 v124, -v144, -v145
v_cvt_pk_bf16_f32 v125, -v146, -v147
v_cvt_pk_bf16_f32 v126, -v148, -v149
v_cvt_pk_bf16_f32 v127, -v150, -v151
v_xor_b32 v160, v14, v120
v_xor_b32 v161, v14, v121
v_xor_b32 v162, v14, v122
v_xor_b32 v163, v14, v123
v_xor_b32 v164, v13, v124
v_xor_b32 v165, v13, v125
v_xor_b32 v166, v13, v126
v_xor_b32 v167, v13, v127
ds_write_b128 v15, v[160:163] offset:14336
ds_write_b128 v16, v[164:167] offset:14336
s_waitcnt vmcnt(0)
s_xor_b32 s53, s2, 255
s_or_b32 s53, s53, s48
s_cmp_lg_u32 s53, 0
s_cbranch_scc1 Lnoinit2
v_mov_b32 v4, 1
v_mov_b32 v7, 0
s_mov_b64 exec, 1
buffer_store_dword v4, v7, s[32:35], 0 offen sc1
s_mov_b64 exec, -1
Lnoinit2:
v_mov_b32 v15, 14336
v_mov_b32 v16, 0
v_mov_b32 v17, 0
v_mov_b32 v18, 0
v_mov_b32 v19, 0
v_add_u32_e64 v14, s46, v15
v_add_u32 v8, 65536, v8
v_add_u32 v9, 65536, v9
v_add_u32 v10, 65536, v10
v_add_u32 v11, 65536, v11
s_waitcnt lgkmcnt(0)
s_barrier
ds_read_b128 v[48:51], v8 offset:0
ds_read_b128 v[52:55], v8 offset:4096
ds_read_b128 v[56:59], v8 offset:8192
ds_read_b128 v[60:63], v8 offset:12288
s_and_b32 s60, s2, 7
s_lshl_b32 s60, s60, 2
s_lshr_b32 s9, s2, 6
s_add_u32 s60, s60, s9
s_lshl_b32 s62, s60, 1
s_add_u32 s62, s62, s61
s_and_b32 s62, s62, 7
s_mul_i32 s62, s62, 11
s_lshr_b32 s62, s62, 2
s_mul_i32 s71, s48, 360448
s_lshl_b32 s53, s61, 7
s_add_u32 s71, s71, s53
s_add_u32 s64, s71, 360448
s_lshl_b32 s47, s62, 14
s_add_u32 s47, s47, s71
s_add_u32 s47, s47, 114688
s_sub_u32 s53, s47, 360448
s_cmp_ge_u32 s47, s64
s_cselect_b32 s47, s53, s47
s_waitcnt lgkmcnt(3)
v_mfma_f32_32x32x16_bf16 v[128:143], v[48:51], v[64:67], 0
v_mfma_f32_32x32x16_bf16 v[144:159], v[48:51], v[68:71], 0
ds_read_b128 v[48:51], v9 offset:0
s_waitcnt lgkmcnt(3)
v_mfma_f32_32x32x16_bf16 v[160:175], v[52:55], v[64:67], 0
v_mfma_f32_32x32x16_bf16 v[176:191], v[52:55], v[68:71], 0
ds_read_b128 v[52:55], v9 offset:4096
s_waitcnt lgkmcnt(3)
v_mfma_f32_32x32x16_bf16 v[192:207], v[56:59], v[64:67], 0
v_mfma_f32_32x32x16_bf16 v[208:223], v[56:59], v[68:71], 0
ds_read_b128 v[56:59], v9 offset:8192
s_waitcnt lgkmcnt(3)
v_mfma_f32_32x32x16_bf16 v[224:239], v[60:63], v[64:67], 0
v_mfma_f32_32x32x16_bf16 v[240:255], v[60:63], v[68:71], 0
ds_read_b128 v[60:63], v9 offset:12288
s_waitcnt lgkmcnt(3)
v_mfma_f32_32x32x16_bf16 v[128:143], v[48:51], v[72:75], v[128:143]
v_mfma_f32_32x32x16_bf16 v[144:159], v[48:51], v[76:79], v[144:159]
ds_read_b128 v[48:51], v10 offset:0
s_waitcnt lgkmcnt(3)
v_mfma_f32_32x32x16_bf16 v[160:175], v[52:55], v[72:75], v[160:175]
v_mfma_f32_32x32x16_bf16 v[176:191], v[52:55], v[76:79], v[176:191]
ds_read_b128 v[52:55], v10 offset:4096
s_waitcnt lgkmcnt(3)
v_mfma_f32_32x32x16_bf16 v[192:207], v[56:59], v[72:75], v[192:207]
v_mfma_f32_32x32x16_bf16 v[208:223], v[56:59], v[76:79], v[208:223]
ds_read_b128 v[56:59], v10 offset:8192
s_waitcnt lgkmcnt(3)
v_mfma_f32_32x32x16_bf16 v[224:239], v[60:63], v[72:75], v[224:239]
v_mfma_f32_32x32x16_bf16 v[240:255], v[60:63], v[76:79], v[240:255]
ds_read_b128 v[60:63], v10 offset:12288
s_waitcnt lgkmcnt(3)
v_mfma_f32_32x32x16_bf16 v[128:143], v[48:51], v[80:83], v[128:143]
v_mfma_f32_32x32x16_bf16 v[144:159], v[48:51], v[84:87], v[144:159]
ds_read_b128 v[48:51], v11 offset:0
s_waitcnt lgkmcnt(3)
v_mfma_f32_32x32x16_bf16 v[160:175], v[52:55], v[80:83], v[160:175]
v_mfma_f32_32x32x16_bf16 v[176:191], v[52:55], v[84:87], v[176:191]
ds_read_b128 v[52:55], v11 offset:4096
s_waitcnt lgkmcnt(3)
v_mfma_f32_32x32x16_bf16 v[192:207], v[56:59], v[80:83], v[192:207]
v_mfma_f32_32x32x16_bf16 v[208:223], v[56:59], v[84:87], v[208:223]
ds_read_b128 v[56:59], v11 offset:8192
s_waitcnt lgkmcnt(3)
v_mfma_f32_32x32x16_bf16 v[224:239], v[60:63], v[80:83], v[224:239]
v_mfma_f32_32x32x16_bf16 v[240:255], v[60:63], v[84:87], v[240:255]
ds_read_b128 v[60:63], v11 offset:12288
ds_read_b128 v[64:67], v12 offset:0
ds_read_b128 v[68:71], v12 offset:1024
s_waitcnt lgkmcnt(5)
v_mfma_f32_32x32x16_bf16 v[128:143], v[48:51], v[88:91], v[128:143]
v_mfma_f32_32x32x16_bf16 v[144:159], v[48:51], v[92:95], v[144:159]
ds_read_b128 v[48:51], v8 offset:16384
s_waitcnt lgkmcnt(5)
v_mfma_f32_32x32x16_bf16 v[160:175], v[52:55], v[88:91], v[160:175]
v_mfma_f32_32x32x16_bf16 v[176:191], v[52:55], v[92:95], v[176:191]
ds_read_b128 v[52:55], v8 offset:20480
s_waitcnt lgkmcnt(5)
v_mfma_f32_32x32x16_bf16 v[192:207], v[56:59], v[88:91], v[192:207]
v_mfma_f32_32x32x16_bf16 v[208:223], v[56:59], v[92:95], v[208:223]
ds_read_b128 v[56:59], v8 offset:24576
s_waitcnt lgkmcnt(5)
v_mfma_f32_32x32x16_bf16 v[224:239], v[60:63], v[88:91], v[224:239]
v_mfma_f32_32x32x16_bf16 v[240:255], v[60:63], v[92:95], v[240:255]
ds_read_b128 v[60:63], v8 offset:28672
ds_read_b128 v[72:75], v12 offset:2048
ds_read_b128 v[76:79], v12 offset:3072
s_waitcnt lgkmcnt(5)
v_mfma_f32_32x32x16_bf16 v[128:143], v[48:51], v[96:99], v[128:143]
v_mfma_f32_32x32x16_bf16 v[144:159], v[48:51], v[100:103], v[144:159]
ds_read_b128 v[48:51], v9 offset:16384
s_waitcnt lgkmcnt(5)
v_mfma_f32_32x32x16_bf16 v[160:175], v[52:55], v[96:99], v[160:175]
v_mfma_f32_32x32x16_bf16 v[176:191], v[52:55], v[100:103], v[176:191]
ds_read_b128 v[52:55], v9 offset:20480
s_waitcnt lgkmcnt(5)
v_mfma_f32_32x32x16_bf16 v[192:207], v[56:59], v[96:99], v[192:207]
v_mfma_f32_32x32x16_bf16 v[208:223], v[56:59], v[100:103], v[208:223]
ds_read_b128 v[56:59], v9 offset:24576
s_waitcnt lgkmcnt(5)
v_mfma_f32_32x32x16_bf16 v[224:239], v[60:63], v[96:99], v[224:239]
v_mfma_f32_32x32x16_bf16 v[240:255], v[60:63], v[100:103], v[240:255]
ds_read_b128 v[60:63], v9 offset:28672
ds_read_b128 v[80:83], v12 offset:4096
ds_read_b128 v[84:87], v12 offset:5120
s_waitcnt lgkmcnt(5)
v_mfma_f32_32x32x16_bf16 v[128:143], v[48:51], v[104:107], v[128:143]
v_mfma_f32_32x32x16_bf16 v[144:159], v[48:51], v[108:111], v[144:159]
ds_read_b128 v[48:51], v10 offset:16384
s_waitcnt lgkmcnt(5)
v_mfma_f32_32x32x16_bf16 v[160:175], v[52:55], v[104:107], v[160:175]
v_mfma_f32_32x32x16_bf16 v[176:191], v[52:55], v[108:111], v[176:191]
ds_read_b128 v[52:55], v10 offset:20480
s_waitcnt lgkmcnt(5)
v_mfma_f32_32x32x16_bf16 v[192:207], v[56:59], v[104:107], v[192:207]
v_mfma_f32_32x32x16_bf16 v[208:223], v[56:59], v[108:111], v[208:223]
ds_read_b128 v[56:59], v10 offset:24576
s_waitcnt lgkmcnt(5)
v_mfma_f32_32x32x16_bf16 v[224:239], v[60:63], v[104:107], v[224:239]
v_mfma_f32_32x32x16_bf16 v[240:255], v[60:63], v[108:111], v[240:255]
ds_read_b128 v[60:63], v10 offset:28672
ds_read_b128 v[88:91], v12 offset:6144
ds_read_b128 v[92:95], v12 offset:7168
s_waitcnt lgkmcnt(5)
v_mfma_f32_32x32x16_bf16 v[128:143], v[48:51], v[112:115], v[128:143]
v_mfma_f32_32x32x16_bf16 v[144:159], v[48:51], v[116:119], v[144:159]
ds_read_b128 v[48:51], v11 offset:16384
s_waitcnt lgkmcnt(5)
v_mfma_f32_32x32x16_bf16 v[160:175], v[52:55], v[112:115], v[160:175]
v_mfma_f32_32x32x16_bf16 v[176:191], v[52:55], v[116:119], v[176:191]
ds_read_b128 v[52:55], v11 offset:20480
s_waitcnt lgkmcnt(5)
v_mfma_f32_32x32x16_bf16 v[192:207], v[56:59], v[112:115], v[192:207]
v_mfma_f32_32x32x16_bf16 v[208:223], v[56:59], v[116:119], v[208:223]
ds_read_b128 v[56:59], v11 offset:24576
s_waitcnt lgkmcnt(5)
v_mfma_f32_32x32x16_bf16 v[224:239], v[60:63], v[112:115], v[224:239]
v_mfma_f32_32x32x16_bf16 v[240:255], v[60:63], v[116:119], v[240:255]
ds_read_b128 v[60:63], v11 offset:28672
ds_read_b128 v[96:99], v12 offset:8192
ds_read_b128 v[100:103], v12 offset:9216
s_waitcnt lgkmcnt(5)
v_mfma_f32_32x32x16_bf16 v[128:143], v[48:51], v[120:123], v[128:143]
v_mfma_f32_32x32x16_bf16 v[144:159], v[48:51], v[124:127], v[144:159]
s_barrier
ds_read_b128 v[48:51], v8 offset:32768
s_waitcnt lgkmcnt(5)
v_mfma_f32_32x32x16_bf16 v[160:175], v[52:55], v[120:123], v[160:175]
v_mfma_f32_32x32x16_bf16 v[176:191], v[52:55], v[124:127], v[176:191]
ds_read_b128 v[52:55], v8 offset:36864
s_waitcnt lgkmcnt(5)
v_mfma_f32_32x32x16_bf16 v[192:207], v[56:59], v[120:123], v[192:207]
v_mfma_f32_32x32x16_bf16 v[208:223], v[56:59], v[124:127], v[208:223]
ds_read_b128 v[56:59], v8 offset:40960
s_waitcnt lgkmcnt(5)
v_mfma_f32_32x32x16_bf16 v[224:239], v[60:63], v[120:123], v[224:239]
v_mfma_f32_32x32x16_bf16 v[240:255], v[60:63], v[124:127], v[240:255]
ds_read_b128 v[60:63], v8 offset:45056
ds_read_b128 v[104:107], v12 offset:10240
ds_read_b128 v[108:111], v12 offset:11264
s_waitcnt lgkmcnt(5)
v_mfma_f32_32x32x16_bf16 v[128:143], v[48:51], v[64:67], v[128:143]
v_mfma_f32_32x32x16_bf16 v[144:159], v[48:51], v[68:71], v[144:159]
ds_read_b128 v[48:51], v9 offset:32768
s_waitcnt lgkmcnt(5)
v_mfma_f32_32x32x16_bf16 v[160:175], v[52:55], v[64:67], v[160:175]
v_mfma_f32_32x32x16_bf16 v[176:191], v[52:55], v[68:71], v[176:191]
ds_read_b128 v[52:55], v9 offset:36864
s_waitcnt lgkmcnt(5)
v_mfma_f32_32x32x16_bf16 v[192:207], v[56:59], v[64:67], v[192:207]
v_mfma_f32_32x32x16_bf16 v[208:223], v[56:59], v[68:71], v[208:223]
ds_read_b128 v[56:59], v9 offset:40960
s_waitcnt lgkmcnt(5)
v_mfma_f32_32x32x16_bf16 v[224:239], v[60:63], v[64:67], v[224:239]
v_mfma_f32_32x32x16_bf16 v[240:255], v[60:63], v[68:71], v[240:255]
ds_read_b128 v[60:63], v9 offset:45056
ds_read_b128 v[112:115], v12 offset:12288
ds_read_b128 v[116:119], v12 offset:13312
s_waitcnt lgkmcnt(5)
v_mfma_f32_32x32x16_bf16 v[128:143], v[48:51], v[72:75], v[128:143]
v_mfma_f32_32x32x16_bf16 v[144:159], v[48:51], v[76:79], v[144:159]
ds_read_b128 v[48:51], v10 offset:32768
s_waitcnt lgkmcnt(5)
v_mfma_f32_32x32x16_bf16 v[160:175], v[52:55], v[72:75], v[160:175]
v_mfma_f32_32x32x16_bf16 v[176:191], v[52:55], v[76:79], v[176:191]
ds_read_b128 v[52:55], v10 offset:36864
s_waitcnt lgkmcnt(5)
v_mfma_f32_32x32x16_bf16 v[192:207], v[56:59], v[72:75], v[192:207]
v_mfma_f32_32x32x16_bf16 v[208:223], v[56:59], v[76:79], v[208:223]
ds_read_b128 v[56:59], v10 offset:40960
s_waitcnt lgkmcnt(5)
v_mfma_f32_32x32x16_bf16 v[224:239], v[60:63], v[72:75], v[224:239]
v_mfma_f32_32x32x16_bf16 v[240:255], v[60:63], v[76:79], v[240:255]
ds_read_b128 v[60:63], v10 offset:45056
ds_read_b128 v[120:123], v12 offset:14336
ds_read_b128 v[124:127], v12 offset:15360
s_waitcnt lgkmcnt(5)
v_mfma_f32_32x32x16_bf16 v[128:143], v[48:51], v[80:83], v[128:143]
v_mfma_f32_32x32x16_bf16 v[144:159], v[48:51], v[84:87], v[144:159]
ds_read_b128 v[48:51], v11 offset:32768
s_waitcnt lgkmcnt(5)
v_mfma_f32_32x32x16_bf16 v[160:175], v[52:55], v[80:83], v[160:175]
v_mfma_f32_32x32x16_bf16 v[176:191], v[52:55], v[84:87], v[176:191]
ds_read_b128 v[52:55], v11 offset:36864
s_waitcnt lgkmcnt(5)
v_mfma_f32_32x32x16_bf16 v[192:207], v[56:59], v[80:83], v[192:207]
v_mfma_f32_32x32x16_bf16 v[208:223], v[56:59], v[84:87], v[208:223]
ds_read_b128 v[56:59], v11 offset:40960
s_waitcnt lgkmcnt(5)
v_mfma_f32_32x32x16_bf16 v[224:239], v[60:63], v[80:83], v[224:239]
v_mfma_f32_32x32x16_bf16 v[240:255], v[60:63], v[84:87], v[240:255]
ds_read_b128 v[60:63], v11 offset:45056
s_waitcnt lgkmcnt(3)
v_mfma_f32_32x32x16_bf16 v[128:143], v[48:51], v[88:91], v[128:143]
v_mfma_f32_32x32x16_bf16 v[144:159], v[48:51], v[92:95], v[144:159]
ds_write_b128 v14, v[16:19]
ds_write_b128 v14, v[16:19] offset:16
s_waitcnt lgkmcnt(0)
s_barrier
s_setprio 1
ds_read_b128 v[48:51], v8 offset:0
v_mfma_f32_32x32x16_bf16 v[160:175], v[52:55], v[88:91], v[160:175]
v_mfma_f32_32x32x16_bf16 v[176:191], v[52:55], v[92:95], v[176:191]
ds_read_b128 v[52:55], v8 offset:4096
v_mfma_f32_32x32x16_bf16 v[192:207], v[56:59], v[88:91], v[192:207]
v_mfma_f32_32x32x16_bf16 v[208:223], v[56:59], v[92:95], v[208:223]
ds_read_b128 v[56:59], v8 offset:8192
v_mfma_f32_32x32x16_bf16 v[224:239], v[60:63], v[88:91], v[224:239]
v_mfma_f32_32x32x16_bf16 v[240:255], v[60:63], v[92:95], v[240:255]
ds_read_b128 v[60:63], v8 offset:12288
s_waitcnt lgkmcnt(3)
v_mfma_f32_32x32x16_bf16 v[128:143], v[48:51], v[96:99], v[128:143]
v_mfma_f32_32x32x16_bf16 v[144:159], v[48:51], v[100:103], v[144:159]
ds_read_b128 v[48:51], v9 offset:0
s_waitcnt lgkmcnt(3)
v_mfma_f32_32x32x16_bf16 v[160:175], v[52:55], v[96:99], v[160:175]
v_mfma_f32_32x32x16_bf16 v[176:191], v[52:55], v[100:103], v[176:191]
ds_read_b128 v[52:55], v9 offset:4096
s_waitcnt lgkmcnt(3)
v_mfma_f32_32x32x16_bf16 v[192:207], v[56:59], v[96:99], v[192:207]
v_mfma_f32_32x32x16_bf16 v[208:223], v[56:59], v[100:103], v[208:223]
ds_read_b128 v[56:59], v9 offset:8192
s_waitcnt lgkmcnt(3)
v_mfma_f32_32x32x16_bf16 v[224:239], v[60:63], v[96:99], v[224:239]
v_mfma_f32_32x32x16_bf16 v[240:255], v[60:63], v[100:103], v[240:255]
ds_read_b128 v[60:63], v9 offset:12288
s_waitcnt lgkmcnt(3)
v_mfma_f32_32x32x16_bf16 v[128:143], v[48:51], v[104:107], v[128:143]
v_mfma_f32_32x32x16_bf16 v[144:159], v[48:51], v[108:111], v[144:159]
ds_read_b128 v[48:51], v10 offset:0
s_waitcnt lgkmcnt(3)
v_mfma_f32_32x32x16_bf16 v[160:175], v[52:55], v[104:107], v[160:175]
v_mfma_f32_32x32x16_bf16 v[176:191], v[52:55], v[108:111], v[176:191]
ds_read_b128 v[52:55], v10 offset:4096
s_waitcnt lgkmcnt(3)
v_mfma_f32_32x32x16_bf16 v[192:207], v[56:59], v[104:107], v[192:207]
v_mfma_f32_32x32x16_bf16 v[208:223], v[56:59], v[108:111], v[208:223]
ds_read_b128 v[56:59], v10 offset:8192
s_waitcnt lgkmcnt(3)
v_mfma_f32_32x32x16_bf16 v[224:239], v[60:63], v[104:107], v[224:239]
v_mfma_f32_32x32x16_bf16 v[240:255], v[60:63], v[108:111], v[240:255]
ds_read_b128 v[60:63], v10 offset:12288
s_waitcnt lgkmcnt(3)
v_mfma_f32_32x32x16_bf16 v[128:143], v[48:51], v[112:115], v[128:143]
v_mfma_f32_32x32x16_bf16 v[144:159], v[48:51], v[116:119], v[144:159]
ds_read_b128 v[48:51], v11 offset:0
s_waitcnt lgkmcnt(3)
v_mfma_f32_32x32x16_bf16 v[160:175], v[52:55], v[112:115], v[160:175]
v_mfma_f32_32x32x16_bf16 v[176:191], v[52:55], v[116:119], v[176:191]
ds_read_b128 v[52:55], v11 offset:4096
s_waitcnt lgkmcnt(3)
v_mfma_f32_32x32x16_bf16 v[192:207], v[56:59], v[112:115], v[192:207]
v_mfma_f32_32x32x16_bf16 v[208:223], v[56:59], v[116:119], v[208:223]
ds_read_b128 v[56:59], v11 offset:8192
s_waitcnt lgkmcnt(3)
v_mfma_f32_32x32x16_bf16 v[224:239], v[60:63], v[112:115], v[224:239]
v_mfma_f32_32x32x16_bf16 v[240:255], v[60:63], v[116:119], v[240:255]
ds_read_b128 v[60:63], v11 offset:12288
s_waitcnt lgkmcnt(3)
v_mfma_f32_32x32x16_bf16 v[128:143], v[48:51], v[120:123], v[128:143]
v_mfma_f32_32x32x16_bf16 v[144:159], v[48:51], v[124:127], v[144:159]
s_waitcnt lgkmcnt(2)
v_mfma_f32_32x32x16_bf16 v[160:175], v[52:55], v[120:123], v[160:175]
v_mfma_f32_32x32x16_bf16 v[176:191], v[52:55], v[124:127], v[176:191]
s_waitcnt lgkmcnt(1)
v_mfma_f32_32x32x16_bf16 v[192:207], v[56:59], v[120:123], v[192:207]
v_mfma_f32_32x32x16_bf16 v[208:223], v[56:59], v[124:127], v[208:223]
s_waitcnt lgkmcnt(0)
v_mfma_f32_32x32x16_bf16 v[224:239], v[60:63], v[120:123], v[224:239]
v_mfma_f32_32x32x16_bf16 v[240:255], v[60:63], v[124:127], v[240:255]
v_mov_b32 v4, 16
s_mov_b64 exec, 1
ds_add_u32 v15, v4 offset:12
s_mov_b64 exec, -1
s_lshl_b32 s55, s49, 12
s_lshl_b32 s54, s59, 11
s_add_u32 s55, s55, s54
s_lshl_b32 s54, s48, 9
s_add_u32 s55, s55, s54
s_add_u32 s55, s55, 6295552
v_lshrrev_b32 v8, 5, v0
v_lshlrev_b32 v8, 18, v8
v_and_b32_e64 v9, 31, v0
v_lshl_add_u32 v8, v9, 4, v8
s_lshl_b32 s69, s49, 1
s_add_u32 s69, s69, s59
s_lshl_b32 s69, s69, 2
s_add_u32 s69, s69, 8400896
v_cvt_pk_bf16_f32 v48, v128, v129
v_cvt_pk_bf16_f32 v49, v130, v131
v_cvt_pk_bf16_f32 v50, v132, v133
v_cvt_pk_bf16_f32 v51, v134, v135
v_cvt_pk_bf16_f32 v52, v136, v137
v_cvt_pk_bf16_f32 v53, v138, v139
v_cvt_pk_bf16_f32 v54, v140, v141
v_cvt_pk_bf16_f32 v55, v142, v143
v_cvt_pk_bf16_f32 v56, v144, v145
v_cvt_pk_bf16_f32 v57, v146, v147
v_cvt_pk_bf16_f32 v58, v148, v149
v_cvt_pk_bf16_f32 v59, v150, v151
v_cvt_pk_bf16_f32 v60, v152, v153
v_cvt_pk_bf16_f32 v61, v154, v155
v_cvt_pk_bf16_f32 v62, v156, v157
v_cvt_pk_bf16_f32 v63, v158, v159
s_nop 1
v_mfma_f32_32x32x16_bf16 v[128:143], v[24:27], v[48:51], 0
v_mfma_f32_32x32x16_bf16 v[144:159], v[24:27], v[56:59], 0
v_mfma_f32_32x32x16_bf16 v[128:143], v[28:31], v[52:55], v[128:143]
v_mfma_f32_32x32x16_bf16 v[144:159], v[28:31], v[60:63], v[144:159]
v_mfma_f32_32x32x16_bf16 v[128:143], v[32:35], v[56:59], v[128:143]
v_mfma_f32_32x32x16_bf16 v[144:159], v[40:43], v[48:51], v[144:159]
v_mfma_f32_32x32x16_bf16 v[128:143], v[36:39], v[60:63], v[128:143]
v_mfma_f32_32x32x16_bf16 v[144:159], v[44:47], v[52:55], v[144:159]
v_cvt_pk_bf16_f32 v48, v160, v161
v_cvt_pk_bf16_f32 v49, v162, v163
v_cvt_pk_bf16_f32 v50, v164, v165
v_cvt_pk_bf16_f32 v51, v166, v167
v_cvt_pk_bf16_f32 v52, v168, v169
v_cvt_pk_bf16_f32 v53, v170, v171
v_cvt_pk_bf16_f32 v54, v172, v173
v_cvt_pk_bf16_f32 v55, v174, v175
v_cvt_pk_bf16_f32 v56, v176, v177
v_cvt_pk_bf16_f32 v57, v178, v179
v_cvt_pk_bf16_f32 v58, v180, v181
v_cvt_pk_bf16_f32 v59, v182, v183
v_cvt_pk_bf16_f32 v60, v184, v185
v_cvt_pk_bf16_f32 v61, v186, v187
v_cvt_pk_bf16_f32 v62, v188, v189
v_cvt_pk_bf16_f32 v63, v190, v191
s_nop 1
v_mfma_f32_32x32x16_bf16 v[160:175], v[24:27], v[48:51], 0
v_cvt_pk_bf16_f32 v64, v128, v144
v_cvt_pk_bf16_f32 v68, v129, v145
v_cvt_pk_bf16_f32 v72, v130, v146
v_cvt_pk_bf16_f32 v76, v131, v147
v_mfma_f32_32x32x16_bf16 v[176:191], v[24:27], v[56:59], 0
v_cvt_pk_bf16_f32 v80, v132, v148
v_cvt_pk_bf16_f32 v84, v133, v149
v_cvt_pk_bf16_f32 v88, v134, v150
v_cvt_pk_bf16_f32 v92, v135, v151
v_mfma_f32_32x32x16_bf16 v[160:175], v[28:31], v[52:55], v[160:175]
v_cvt_pk_bf16_f32 v96, v136, v152
v_cvt_pk_bf16_f32 v100, v137, v153
v_cvt_pk_bf16_f32 v104, v138, v154
v_cvt_pk_bf16_f32 v108, v139, v155
v_mfma_f32_32x32x16_bf16 v[176:191], v[28:31], v[60:63], v[176:191]
v_cvt_pk_bf16_f32 v112, v140, v156
v_cvt_pk_bf16_f32 v116, v141, v157
v_cvt_pk_bf16_f32 v120, v142, v158
v_cvt_pk_bf16_f32 v124, v143, v159
v_mfma_f32_32x32x16_bf16 v[160:175], v[32:35], v[56:59], v[160:175]
v_cvt_pk_bf16_f32 v128, v192, v193
v_cvt_pk_bf16_f32 v129, v194, v195
v_cvt_pk_bf16_f32 v130, v196, v197
v_cvt_pk_bf16_f32 v131, v198, v199
v_mfma_f32_32x32x16_bf16 v[176:191], v[40:43], v[48:51], v[176:191]
v_cvt_pk_bf16_f32 v132, v200, v201
v_cvt_pk_bf16_f32 v133, v202, v203
v_cvt_pk_bf16_f32 v134, v204, v205
v_cvt_pk_bf16_f32 v135, v206, v207
v_mfma_f32_32x32x16_bf16 v[160:175], v[36:39], v[60:63], v[160:175]
v_cvt_pk_bf16_f32 v136, v208, v209
v_cvt_pk_bf16_f32 v137, v210, v211
v_cvt_pk_bf16_f32 v138, v212, v213
v_cvt_pk_bf16_f32 v139, v214, v215
v_mfma_f32_32x32x16_bf16 v[176:191], v[44:47], v[52:55], v[176:191]
v_cvt_pk_bf16_f32 v140, v216, v217
v_cvt_pk_bf16_f32 v141, v218, v219
v_cvt_pk_bf16_f32 v142, v220, v221
v_cvt_pk_bf16_f32 v143, v222, v223
s_nop 1
v_mfma_f32_32x32x16_bf16 v[192:207], v[24:27], v[128:131], 0
v_cvt_pk_bf16_f32 v48, v224, v225
v_cvt_pk_bf16_f32 v49, v226, v227
v_cvt_pk_bf16_f32 v50, v228, v229
v_cvt_pk_bf16_f32 v51, v230, v231
v_mfma_f32_32x32x16_bf16 v[208:223], v[24:27], v[136:139], 0
v_cvt_pk_bf16_f32 v52, v232, v233
v_cvt_pk_bf16_f32 v53, v234, v235
v_cvt_pk_bf16_f32 v54, v236, v237
v_cvt_pk_bf16_f32 v55, v238, v239
v_mfma_f32_32x32x16_bf16 v[192:207], v[28:31], v[132:135], v[192:207]
v_cvt_pk_bf16_f32 v56, v240, v241
v_cvt_pk_bf16_f32 v57, v242, v243
v_cvt_pk_bf16_f32 v58, v244, v245
v_cvt_pk_bf16_f32 v59, v246, v247
v_mfma_f32_32x32x16_bf16 v[208:223], v[28:31], v[140:143], v[208:223]
v_cvt_pk_bf16_f32 v60, v248, v249
v_cvt_pk_bf16_f32 v61, v250, v251
v_cvt_pk_bf16_f32 v62, v252, v253
v_cvt_pk_bf16_f32 v63, v254, v255
v_mfma_f32_32x32x16_bf16 v[192:207], v[32:35], v[136:139], v[192:207]
v_cvt_pk_bf16_f32 v65, v160, v176
v_cvt_pk_bf16_f32 v69, v161, v177
v_cvt_pk_bf16_f32 v73, v162, v178
v_cvt_pk_bf16_f32 v77, v163, v179
v_mfma_f32_32x32x16_bf16 v[208:223], v[40:43], v[128:131], v[208:223]
v_cvt_pk_bf16_f32 v81, v164, v180
v_cvt_pk_bf16_f32 v85, v165, v181
v_cvt_pk_bf16_f32 v89, v166, v182
v_cvt_pk_bf16_f32 v93, v167, v183
v_mfma_f32_32x32x16_bf16 v[192:207], v[36:39], v[140:143], v[192:207]
v_cvt_pk_bf16_f32 v97, v168, v184
v_cvt_pk_bf16_f32 v101, v169, v185
v_cvt_pk_bf16_f32 v105, v170, v186
v_cvt_pk_bf16_f32 v109, v171, v187
v_mfma_f32_32x32x16_bf16 v[208:223], v[44:47], v[132:135], v[208:223]
v_cvt_pk_bf16_f32 v113, v172, v188
v_cvt_pk_bf16_f32 v117, v173, v189
v_cvt_pk_bf16_f32 v121, v174, v190
v_cvt_pk_bf16_f32 v125, v175, v191
v_mfma_f32_32x32x16_bf16 v[224:239], v[24:27], v[48:51], 0
s_nop 7
s_nop 3
v_mfma_f32_32x32x16_bf16 v[240:255], v[24:27], v[56:59], 0
v_cvt_pk_bf16_f32 v66, v192, v208
v_cvt_pk_bf16_f32 v70, v193, v209
v_mfma_f32_32x32x16_bf16 v[224:239], v[28:31], v[52:55], v[224:239]
v_cvt_pk_bf16_f32 v74, v194, v210
v_cvt_pk_bf16_f32 v78, v195, v211
v_mfma_f32_32x32x16_bf16 v[240:255], v[28:31], v[60:63], v[240:255]
v_cvt_pk_bf16_f32 v82, v196, v212
v_cvt_pk_bf16_f32 v86, v197, v213
v_cvt_pk_bf16_f32 v90, v198, v214
v_mfma_f32_32x32x16_bf16 v[224:239], v[32:35], v[56:59], v[224:239]
v_cvt_pk_bf16_f32 v94, v199, v215
v_cvt_pk_bf16_f32 v98, v200, v216
v_mfma_f32_32x32x16_bf16 v[240:255], v[40:43], v[48:51], v[240:255]
v_cvt_pk_bf16_f32 v102, v201, v217
v_cvt_pk_bf16_f32 v106, v202, v218
v_mfma_f32_32x32x16_bf16 v[224:239], v[36:39], v[60:63], v[224:239]
v_cvt_pk_bf16_f32 v110, v203, v219
v_cvt_pk_bf16_f32 v114, v204, v220
v_mfma_f32_32x32x16_bf16 v[240:255], v[44:47], v[52:55], v[240:255]
v_cvt_pk_bf16_f32 v118, v205, v221
v_cvt_pk_bf16_f32 v122, v206, v222
v_cvt_pk_bf16_f32 v126, v207, v223
v_mov_b32_e64 v30, 0
buffer_load_dword v31, v30, s[32:35], 0 offen sc1
s_nop 9
v_cvt_pk_bf16_f32 v67, v224, v240
s_add_u32 s56, s55, 0
buffer_store_dwordx4 v[64:67], v8, s[36:39], s56 offen sc1
v_cvt_pk_bf16_f32 v71, v225, v241
s_add_u32 s56, s55, 65536
buffer_store_dwordx4 v[68:71], v8, s[36:39], s56 offen sc1
v_cvt_pk_bf16_f32 v75, v226, v242
s_add_u32 s56, s55, 131072
buffer_store_dwordx4 v[72:75], v8, s[36:39], s56 offen sc1
v_cvt_pk_bf16_f32 v79, v227, v243
s_add_u32 s56, s55, 196608
buffer_store_dwordx4 v[76:79], v8, s[36:39], s56 offen sc1
v_cvt_pk_bf16_f32 v83, v228, v244
s_add_u32 s56, s55, 524288
buffer_store_dwordx4 v[80:83], v8, s[36:39], s56 offen sc1
v_cvt_pk_bf16_f32 v87, v229, v245
s_add_u32 s56, s55, 589824
buffer_store_dwordx4 v[84:87], v8, s[36:39], s56 offen sc1
v_cvt_pk_bf16_f32 v91, v230, v246
s_add_u32 s56, s55, 655360
buffer_store_dwordx4 v[88:91], v8, s[36:39], s56 offen sc1
v_cvt_pk_bf16_f32 v95, v231, v247
s_add_u32 s56, s55, 720896
buffer_store_dwordx4 v[92:95], v8, s[36:39], s56 offen sc1
v_cvt_pk_bf16_f32 v99, v232, v248
s_add_u32 s56, s55, 1048576
buffer_store_dwordx4 v[96:99], v8, s[36:39], s56 offen sc1
v_cvt_pk_bf16_f32 v103, v233, v249
s_add_u32 s56, s55, 1114112
buffer_store_dwordx4 v[100:103], v8, s[36:39], s56 offen sc1
v_cvt_pk_bf16_f32 v107, v234, v250
s_add_u32 s56, s55, 1179648
buffer_store_dwordx4 v[104:107], v8, s[36:39], s56 offen sc1
v_cvt_pk_bf16_f32 v111, v235, v251
s_add_u32 s56, s55, 1245184
buffer_store_dwordx4 v[108:111], v8, s[36:39], s56 offen sc1
v_cvt_pk_bf16_f32 v115, v236, v252
s_add_u32 s56, s55, 1572864
buffer_store_dwordx4 v[112:115], v8, s[36:39], s56 offen sc1
v_cvt_pk_bf16_f32 v119, v237, v253
s_add_u32 s56, s55, 1638400
buffer_store_dwordx4 v[116:119], v8, s[36:39], s56 offen sc1
v_cvt_pk_bf16_f32 v123, v238, v254
s_add_u32 s56, s55, 1703936
buffer_store_dwordx4 v[120:123], v8, s[36:39], s56 offen sc1
v_cvt_pk_bf16_f32 v127, v239, v255
s_add_u32 s56, s55, 1769472
buffer_store_dwordx4 v[124:127], v8, s[36:39], s56 offen sc1
s_waitcnt vmcnt(0)
v_mov_b32 v15, 14336
v_mov_b32 v4, 1
s_mov_b64 exec, 1
ds_add_rtn_u32 v4, v15, v4 offset:4
s_mov_b64 exec, -1
s_waitcnt lgkmcnt(0)
v_readfirstlane_b32 s53, v4
s_and_b32 s53, s53, 3
s_cmp_lg_u32 s53, 3
s_cbranch_scc1 LsBskip
s_mov_b32 s56, 0
LsBpoll:
v_readfirstlane_b32 s53, v31
s_cmp_lg_u32 s53, 0
s_cbranch_scc1 LsBok
s_add_u32 s56, s56, 1
s_cmp_ge_u32 s56, 0x80000
s_cbranch_scc1 LsBok
s_sleep 2
buffer_load_dword v31, v30, s[32:35], 0 offen sc1
s_waitcnt vmcnt(0)
s_branch LsBpoll
LsBok:
v_lshlrev_b32_e64 v29, 9, v0
s_mov_b64 exec, 0xff
buffer_store_dword v31, v29, s[36:39], s69 offen sc1
s_mov_b64 exec, -1
LsBskip:
s_mov_b32 s56, 0
LwE:
ds_read_b32 v4, v15 offset:12
s_waitcnt lgkmcnt(0)
v_readfirstlane_b32 s53, v4
s_add_u32 s56, s56, 1
s_cmp_ge_u32 s56, 0x800000
s_cbranch_scc1 LwEx
s_cmp_ge_u32 s53, 64
s_cbranch_scc1 LwEx
s_sleep 1
s_branch LwE
LwEx:
s_add_u32 m0, s74, 65536
s_add_u32 s53, s47, 16384
buffer_load_dwordx4 v20, s[24:27], s47 offen lds
s_add_u32 m0, s74, 66496
s_add_u32 s53, s47, 16384
buffer_load_dwordx4 v20, s[24:27], s47 offen offset:64 lds
s_cmp_ge_u32 s53, s64
s_cselect_b32 s47, s71, s53
s_add_u32 m0, s74, 67584
s_add_u32 s53, s47, 16384
buffer_load_dwordx4 v20, s[24:27], s47 offen lds
s_add_u32 m0, s74, 68544
s_add_u32 s53, s47, 16384
buffer_load_dwordx4 v20, s[24:27], s47 offen offset:64 lds
s_cmp_ge_u32 s53, s64
s_cselect_b32 s47, s71, s53
s_add_u32 m0, s74, 69632
s_add_u32 s53, s47, 16384
buffer_load_dwordx4 v20, s[24:27], s47 offen lds
s_add_u32 m0, s74, 70592
s_add_u32 s53, s47, 16384
buffer_load_dwordx4 v20, s[24:27], s47 offen offset:64 lds
s_cmp_ge_u32 s53, s64
s_cselect_b32 s47, s71, s53
s_add_u32 m0, s74, 90112
s_add_u32 s53, s47, 16384
buffer_load_dwordx4 v20, s[24:27], s47 offen lds
s_add_u32 m0, s74, 91072
s_add_u32 s53, s47, 16384
buffer_load_dwordx4 v20, s[24:27], s47 offen offset:64 lds
s_cmp_ge_u32 s53, s64
s_cselect_b32 s47, s71, s53
s_add_u32 m0, s74, 92160
s_add_u32 s53, s47, 16384
buffer_load_dwordx4 v20, s[24:27], s47 offen lds
s_add_u32 m0, s74, 93120
s_add_u32 s53, s47, 16384
buffer_load_dwordx4 v20, s[24:27], s47 offen offset:64 lds
s_cmp_ge_u32 s53, s64
s_cselect_b32 s47, s71, s53
s_add_u32 m0, s74, 94208
s_add_u32 s53, s47, 16384
buffer_load_dwordx4 v20, s[24:27], s47 offen lds
s_add_u32 m0, s74, 95168
s_add_u32 s53, s47, 16384
buffer_load_dwordx4 v20, s[24:27], s47 offen offset:64 lds
s_cmp_ge_u32 s53, s64
s_cselect_b32 s47, s71, s53
s_waitcnt vmcnt(0)
v_mov_b32 v4, 1
s_mov_b64 exec, 1
ds_add_u32 v15, v4 offset:20
s_mov_b64 exec, -1
LC2:
s_setprio 0
s_lshr_b32 s53, s48, 1
s_lshl_b32 s53, s53, 5
s_add_u32 s53, s53, s60
v_and_b32 v6, 31, v0
v_lshlrev_b32 v6, 6, v6
v_add_u32 v6, s53, v6
s_and_b32 s54, s48, 1
s_lshl_b32 s54, s54, 5
s_lshl_b32 s55, s61, 6
s_add_u32 s54, s54, s55
s_lshl_b32 s57, s54, 1
v_lshrrev_b32 v7, 5, v0
v_lshlrev_b32 v21, 10, v6
v_lshl_add_u32 v22, v7, 3, v21
v_lshl_add_u32 v21, v7, 4, v21
s_cmp_lt_u32 s61, 4
s_cselect_b32 s72, -1, 1
s_mul_i32 s56, s72, -256
v_and_b32 v23, 31, v0
v_add_u32 v23, s54, v23
v_mul_i32_i24 v23, s72, v23
v_add_u32 v23, s56, v23
v_cmp_eq_u32 vcc, 256, v23
v_and_b32 v24, 1, v23
v_lshrrev_b32 v23, 1, v23
v_lshlrev_b32_e64 v23, 4, v23
v_lshl_add_u32 v23, v24, 11, v23
v_lshl_add_u32 v23, v7, 12, v23
v_mov_b32 v24, 1073741824
v_cndmask_b32 v23, v23, v24, vcc
s_mul_i32 s70, s60, s72
s_and_b32 s70, s70, 31
s_lshl_b32 s70, s70, 16
s_add_u32 s70, s70, 6295552
v_mul_i32_i24 v24, s72, v6
v_cvt_f32_i32_e64 v24, v24
v_mul_f32 v24, 0x3a000000, v24
v_lshlrev_b32 v25, 1, v7
v_cvt_f32_u32 v25, v25
v_mul_f32 v32, v25, v24
v_add_f32 v33, v32, v24
v_fmamk_f32 v34, v24, 0x42000000, v32
v_add_f32 v35, v34, v24
v_mul_f32 v25, 4.0, v24
v_fract_f32 v36, v32
v_fract_f32 v37, v33
v_fract_f32 v38, v34
v_fract_f32 v39, v35
v_cos_f32 v40, v36
v_sin_f32 v41, v36
v_cos_f32 v42, v37
v_sin_f32 v43, v37
v_cos_f32 v44, v38
v_sin_f32 v45, v38
v_cos_f32 v46, v39
v_sin_f32 v47, v39
v_add_f32 v32, v32, v25
v_add_f32 v33, v33, v25
v_add_f32 v34, v34, v25
v_add_f32 v35, v35, v25
v_cvt_pk_bf16_f32 v176, v40, v41
v_cvt_pk_bf16_f32 v177, v42, v43
v_cvt_pk_bf16_f32 v178, v44, v45
v_cvt_pk_bf16_f32 v179, v46, v47
v_fract_f32 v36, v32
v_fract_f32 v37, v33
v_fract_f32 v38, v34
v_fract_f32 v39, v35
v_cos_f32 v40, v36
v_sin_f32 v41, v36
v_cos_f32 v42, v37
v_sin_f32 v43, v37
v_cos_f32 v44, v38
v_sin_f32 v45, v38
v_cos_f32 v46, v39
v_sin_f32 v47, v39
v_add_f32 v32, v32, v25
v_add_f32 v33, v33, v25
v_add_f32 v34, v34, v25
v_add_f32 v35, v35, v25
v_cvt_pk_bf16_f32 v180, v40, v41
v_cvt_pk_bf16_f32 v181, v42, v43
v_cvt_pk_bf16_f32 v182, v44, v45
v_cvt_pk_bf16_f32 v183, v46, v47
v_fract_f32 v36, v32
v_fract_f32 v37, v33
v_fract_f32 v38, v34
v_fract_f32 v39, v35
v_cos_f32 v40, v36
v_sin_f32 v41, v36
v_cos_f32 v42, v37
v_sin_f32 v43, v37
v_cos_f32 v44, v38
v_sin_f32 v45, v38
v_cos_f32 v46, v39
v_sin_f32 v47, v39
v_add_f32 v32, v32, v25
v_add_f32 v33, v33, v25
v_add_f32 v34, v34, v25
v_add_f32 v35, v35, v25
v_cvt_pk_bf16_f32 v184, v40, v41
v_cvt_pk_bf16_f32 v185, v42, v43
v_cvt_pk_bf16_f32 v186, v44, v45
v_cvt_pk_bf16_f32 v187, v46, v47
v_fract_f32 v36, v32
v_fract_f32 v37, v33
v_fract_f32 v38, v34
v_fract_f32 v39, v35
v_cos_f32 v40, v36
v_sin_f32 v41, v36
v_cos_f32 v42, v37
v_sin_f32 v43, v37
v_cos_f32 v44, v38
v_sin_f32 v45, v38
v_cos_f32 v46, v39
v_sin_f32 v47, v39
v_add_f32 v32, v32, v25
v_add_f32 v33, v33, v25
v_add_f32 v34, v34, v25
v_add_f32 v35, v35, v25
v_cvt_pk_bf16_f32 v188, v40, v41
v_cvt_pk_bf16_f32 v189, v42, v43
v_cvt_pk_bf16_f32 v190, v44, v45
v_cvt_pk_bf16_f32 v191, v46, v47
v_fract_f32 v36, v32
v_fract_f32 v37, v33
v_fract_f32 v38, v34
v_fract_f32 v39, v35
v_cos_f32 v40, v36
v_sin_f32 v41, v36
v_cos_f32 v42, v37
v_sin_f32 v43, v37
v_cos_f32 v44, v38
v_sin_f32 v45, v38
v_cos_f32 v46, v39
v_sin_f32 v47, v39
v_add_f32 v32, v32, v25
v_add_f32 v33, v33, v25
v_add_f32 v34, v34, v25
v_add_f32 v35, v35, v25
v_cvt_pk_bf16_f32 v192, v40, v41
v_cvt_pk_bf16_f32 v193, v42, v43
v_cvt_pk_bf16_f32 v194, v44, v45
v_cvt_pk_bf16_f32 v195, v46, v47
v_fract_f32 v36, v32
v_fract_f32 v37, v33
v_fract_f32 v38, v34
v_fract_f32 v39, v35
v_cos_f32 v40, v36
v_sin_f32 v41, v36
v_cos_f32 v42, v37
v_sin_f32 v43, v37
v_cos_f32 v44, v38
v_sin_f32 v45, v38
v_cos_f32 v46, v39
v_sin_f32 v47, v39
v_add_f32 v32, v32, v25
v_add_f32 v33, v33, v25
v_add_f32 v34, v34, v25
v_add_f32 v35, v35, v25
v_cvt_pk_bf16_f32 v196, v40, v41
v_cvt_pk_bf16_f32 v197, v42, v43
v_cvt_pk_bf16_f32 v198, v44, v45
v_cvt_pk_bf16_f32 v199, v46, v47
v_fract_f32 v36, v32
v_fract_f32 v37, v33
v_fract_f32 v38, v34
v_fract_f32 v39, v35
v_cos_f32 v40, v36
v_sin_f32 v41, v36
v_cos_f32 v42, v37
v_sin_f32 v43, v37
v_cos_f32 v44, v38
v_sin_f32 v45, v38
v_cos_f32 v46, v39
v_sin_f32 v47, v39
v_add_f32 v32, v32, v25
v_add_f32 v33, v33, v25
v_add_f32 v34, v34, v25
v_add_f32 v35, v35, v25
v_cvt_pk_bf16_f32 v200, v40, v41
v_cvt_pk_bf16_f32 v201, v42, v43
v_cvt_pk_bf16_f32 v202, v44, v45
v_cvt_pk_bf16_f32 v203, v46, v47
v_fract_f32 v36, v32
v_fract_f32 v37, v33
v_fract_f32 v38, v34
v_fract_f32 v39, v35
v_cos_f32 v40, v36
v_sin_f32 v41, v36
v_cos_f32 v42, v37
v_sin_f32 v43, v37
v_cos_f32 v44, v38
v_sin_f32 v45, v38
v_cos_f32 v46, v39
v_sin_f32 v47, v39
v_add_f32 v32, v32, v25
v_add_f32 v33, v33, v25
v_add_f32 v34, v34, v25
v_add_f32 v35, v35, v25
v_cvt_pk_bf16_f32 v204, v40, v41
v_cvt_pk_bf16_f32 v205, v42, v43
v_cvt_pk_bf16_f32 v206, v44, v45
v_cvt_pk_bf16_f32 v207, v46, v47
buffer_load_dwordx4 v[224:227], v21, s[4:7], s57 offen offset:0
buffer_load_dwordx4 v[228:231], v21, s[4:7], s57 offen offset:32
s_cmp_eq_u32 s48, 3
s_cselect_b32 s53, 4, 3
s_lshl_b32 s53, s53, 12
s_add_u32 s54, s63, 114688
s_cmp_eq_u32 s48, 3
s_cselect_b32 s54, 0, s54
v_lshlrev_b32 v2, 4, v0
v_add_u32 v26, s54, v2
v_add_u32 v27, s53, v26
v_add_u32 v28, s53, v27
v_add_u32 v29, s53, v28
s_lshr_b32 s69, s60, 2
s_lshl_b32 s69, s69, 9
s_add_u32 s69, s69, 8400896
v_lshlrev_b32_e64 v5, 3, v0
v_mov_b32 v15, 14336
v_and_b32 v5, 31, v0
v_lshlrev_b32 v5, 2, v5
s_cmp_lg_u32 s48, 0
s_cbranch_scc1 LBwB
s_mov_b32 s56, 0
LiCpoll:
v_readfirstlane_b32 s53, v31
s_cmp_lg_u32 s53, 0
s_cbranch_scc1 LiCok
s_add_u32 s56, s56, 1
s_cmp_ge_u32 s56, 0x80000
s_cbranch_scc1 LiCok
s_sleep 2
buffer_load_dword v31, v30, s[32:35], 0 offen sc1
s_waitcnt vmcnt(0)
s_branch LiCpoll
LiCok:
buffer_load_dword v16, v5, s[36:39], s69 offen sc1
s_waitcnt vmcnt(0)
v_cmp_eq_u32 vcc, 0, v16
s_nop 1
s_cbranch_vccz LpBdone
s_mov_b32 s56, 0
LwC:
ds_read_b32 v4, v15 offset:0
s_waitcnt lgkmcnt(0)
v_readfirstlane_b32 s53, v4
s_add_u32 s56, s56, 1
s_cmp_ge_u32 s56, 0x800000
s_cbranch_scc1 LwCx
s_cmp_ge_u32 s53, 1
s_cbranch_scc1 LwCx
s_sleep 1
s_branch LwC
LwCx:
s_mov_b32 s56, 0
LpB:
buffer_load_dword v16, v5, s[36:39], s69 offen sc1
s_waitcnt vmcnt(0)
v_cmp_eq_u32 vcc, 0, v16
s_add_u32 s56, s56, 1
s_cmp_ge_u32 s56, 0x80000
s_cbranch_scc1 LpBdone
s_cbranch_vccz LpBdone
s_sleep 16
s_branch LpB
LpBdone:
v_mov_b32_e64 v4, 1
ds_write_b32 v15, v4 offset:8
s_branch LwBx
LBwB:
s_mov_b32 s56, 0
LwB:
ds_read_b32 v4, v15 offset:8
s_waitcnt lgkmcnt(0)
v_readfirstlane_b32 s53, v4
s_add_u32 s56, s56, 1
s_cmp_ge_u32 s56, 0x800000
s_cbranch_scc1 LwBx
s_cmp_ge_u32 s53, 1
s_cbranch_scc1 LwBx
s_sleep 1
s_branch LwB
LwBx:
s_add_u32 s53, s70, 0
buffer_load_dwordx4 v[128:131], v23, s[36:39], s53 offen sc1
s_add_u32 s53, s70, 8192
buffer_load_dwordx4 v[132:135], v23, s[36:39], s53 offen sc1
s_add_u32 s53, s70, 16384
buffer_load_dwordx4 v[136:139], v23, s[36:39], s53 offen sc1
s_add_u32 s53, s70, 24576
buffer_load_dwordx4 v[140:143], v23, s[36:39], s53 offen sc1
s_add_u32 s53, s70, 32768
buffer_load_dwordx4 v[144:147], v23, s[36:39], s53 offen sc1
s_add_u32 s53, s70, 40960
buffer_load_dwordx4 v[148:151], v23, s[36:39], s53 offen sc1
s_add_u32 s53, s70, 49152
buffer_load_dwordx4 v[152:155], v23, s[36:39], s53 offen sc1
s_add_u32 s53, s70, 57344
buffer_load_dwordx4 v[156:159], v23, s[36:39], s53 offen sc1
s_waitcnt vmcnt(8)
v_permlane32_swap_b32 v224, v226
v_permlane32_swap_b32 v225, v227
v_permlane32_swap_b32 v228, v230
v_permlane32_swap_b32 v229, v231
s_nop 1
v_lshlrev_b32 v208, 16, v224
v_and_b32 v209, 0xffff0000, v224
v_lshlrev_b32_e64 v210, 16, v225
v_and_b32 v211, 0xffff0000, v225
v_lshlrev_b32_e64 v212, 16, v226
v_and_b32 v213, 0xffff0000, v226
v_lshlrev_b32_e64 v214, 16, v227
v_and_b32 v215, 0xffff0000, v227
v_lshlrev_b32_e64 v216, 16, v228
v_and_b32 v217, 0xffff0000, v228
v_lshlrev_b32_e64 v218, 16, v229
v_and_b32 v219, 0xffff0000, v229
v_lshlrev_b32_e64 v220, 16, v230
v_and_b32 v221, 0xffff0000, v230
v_lshlrev_b32_e64 v222, 16, v231
v_and_b32 v223, 0xffff0000, v231
s_nop 0
s_waitcnt vmcnt(7)
v_mfma_f32_32x32x16_bf16 v[160:175], v[128:131], v[176:179], 0
s_waitcnt vmcnt(6)
v_mfma_f32_32x32x16_bf16 v[160:175], v[132:135], v[180:183], v[160:175]
s_waitcnt vmcnt(5)
v_mfma_f32_32x32x16_bf16 v[160:175], v[136:139], v[184:187], v[160:175]
s_waitcnt vmcnt(4)
v_mfma_f32_32x32x16_bf16 v[160:175], v[140:143], v[188:191], v[160:175]
s_waitcnt vmcnt(3)
v_mfma_f32_32x32x16_bf16 v[160:175], v[144:147], v[192:195], v[160:175]
s_waitcnt vmcnt(2)
v_mfma_f32_32x32x16_bf16 v[160:175], v[148:151], v[196:199], v[160:175]
s_waitcnt vmcnt(1)
v_mfma_f32_32x32x16_bf16 v[160:175], v[152:155], v[200:203], v[160:175]
s_waitcnt vmcnt(0)
v_mfma_f32_32x32x16_bf16 v[160:175], v[156:159], v[204:207], v[160:175]
s_barrier
ds_read_b128 v[32:35], v26 offset:0
ds_read_b128 v[36:39], v26 offset:1024
ds_read_b128 v[40:43], v26 offset:2048
ds_read_b128 v[44:47], v26 offset:3072
ds_read_b128 v[48:51], v27 offset:0
ds_read_b128 v[52:55], v27 offset:1024
ds_read_b128 v[56:59], v27 offset:2048
ds_read_b128 v[60:63], v27 offset:3072
ds_read_b128 v[64:67], v28 offset:0
ds_read_b128 v[68:71], v28 offset:1024
ds_read_b128 v[72:75], v28 offset:2048
ds_read_b128 v[76:79], v28 offset:3072
ds_read_b128 v[80:83], v29 offset:0
ds_read_b128 v[84:87], v29 offset:1024
ds_read_b128 v[88:91], v29 offset:2048
ds_read_b128 v[92:95], v29 offset:3072
s_waitcnt lgkmcnt(8)
v_pk_add_f32 v[32:33], v[32:33], v[48:49]
v_pk_add_f32 v[34:35], v[34:35], v[50:51]
v_pk_add_f32 v[36:37], v[36:37], v[52:53]
v_pk_add_f32 v[38:39], v[38:39], v[54:55]
v_pk_add_f32 v[40:41], v[40:41], v[56:57]
v_pk_add_f32 v[42:43], v[42:43], v[58:59]
v_pk_add_f32 v[44:45], v[44:45], v[60:61]
v_pk_add_f32 v[46:47], v[46:47], v[62:63]
s_waitcnt lgkmcnt(0)
v_pk_add_f32 v[64:65], v[64:65], v[80:81]
v_pk_add_f32 v[66:67], v[66:67], v[82:83]
v_pk_add_f32 v[68:69], v[68:69], v[84:85]
v_pk_add_f32 v[70:71], v[70:71], v[86:87]
v_pk_add_f32 v[72:73], v[72:73], v[88:89]
v_pk_add_f32 v[74:75], v[74:75], v[90:91]
v_pk_add_f32 v[76:77], v[76:77], v[92:93]
v_pk_add_f32 v[78:79], v[78:79], v[94:95]
v_pk_add_f32 v[64:65], v[64:65], v[32:33]
v_pk_add_f32 v[66:67], v[66:67], v[34:35]
v_pk_add_f32 v[68:69], v[68:69], v[36:37]
v_pk_add_f32 v[70:71], v[70:71], v[38:39]
v_pk_add_f32 v[72:73], v[72:73], v[40:41]
v_pk_add_f32 v[74:75], v[74:75], v[42:43]
v_pk_add_f32 v[76:77], v[76:77], v[44:45]
v_pk_add_f32 v[78:79], v[78:79], v[46:47]
v_pk_mul_f32 v[80:81], v[64:65], s[76:77]
v_pk_mul_f32 v[82:83], v[66:67], s[76:77]
v_pk_mul_f32 v[84:85], v[68:69], s[76:77]
v_pk_mul_f32 v[86:87], v[70:71], s[76:77]
v_pk_mul_f32 v[88:89], v[72:73], s[76:77]
v_pk_mul_f32 v[90:91], v[74:75], s[76:77]
v_pk_mul_f32 v[92:93], v[76:77], s[76:77]
v_pk_mul_f32 v[94:95], v[78:79], s[76:77]
v_exp_f32 v80, v80
v_exp_f32 v81, v81
v_exp_f32 v82, v82
v_exp_f32 v83, v83
v_exp_f32 v84, v84
v_exp_f32 v85, v85
v_exp_f32 v86, v86
v_exp_f32 v87, v87
v_exp_f32 v88, v88
v_exp_f32 v89, v89
v_exp_f32 v90, v90
v_exp_f32 v91, v91
v_exp_f32 v92, v92
v_exp_f32 v93, v93
v_exp_f32 v94, v94
v_exp_f32 v95, v95
v_pk_mul_f32 v[64:65], v[64:65], v[160:161]
v_pk_mul_f32 v[66:67], v[66:67], v[162:163]
v_pk_mul_f32 v[68:69], v[68:69], v[164:165]
v_pk_mul_f32 v[70:71], v[70:71], v[166:167]
v_pk_mul_f32 v[72:73], v[72:73], v[168:169]
v_pk_mul_f32 v[74:75], v[74:75], v[170:171]
v_pk_mul_f32 v[76:77], v[76:77], v[172:173]
v_pk_mul_f32 v[78:79], v[78:79], v[174:175]
v_pk_add_f32 v[80:81], v[80:81], 1.0 op_sel_hi:[1,0]
v_pk_add_f32 v[82:83], v[82:83], 1.0 op_sel_hi:[1,0]
v_pk_add_f32 v[84:85], v[84:85], 1.0 op_sel_hi:[1,0]
v_pk_add_f32 v[86:87], v[86:87], 1.0 op_sel_hi:[1,0]
v_pk_add_f32 v[88:89], v[88:89], 1.0 op_sel_hi:[1,0]
v_pk_add_f32 v[90:91], v[90:91], 1.0 op_sel_hi:[1,0]
v_pk_add_f32 v[92:93], v[92:93], 1.0 op_sel_hi:[1,0]
v_pk_add_f32 v[94:95], v[94:95], 1.0 op_sel_hi:[1,0]
v_rcp_f32 v80, v80
v_rcp_f32 v81, v81
v_rcp_f32 v82, v82
v_rcp_f32 v83, v83
v_rcp_f32 v84, v84
v_rcp_f32 v85, v85
v_rcp_f32 v86, v86
v_rcp_f32 v87, v87
v_rcp_f32 v88, v88
v_rcp_f32 v89, v89
v_rcp_f32 v90, v90
v_rcp_f32 v91, v91
v_rcp_f32 v92, v92
v_rcp_f32 v93, v93
v_rcp_f32 v94, v94
v_rcp_f32 v95, v95
s_nop 0
v_pk_mul_f32 v[64:65], v[64:65], v[80:81]
v_pk_mul_f32 v[66:67], v[66:67], v[82:83]
v_pk_mul_f32 v[68:69], v[68:69], v[84:85]
v_pk_mul_f32 v[70:71], v[70:71], v[86:87]
v_pk_mul_f32 v[72:73], v[72:73], v[88:89]
v_pk_mul_f32 v[74:75], v[74:75], v[90:91]
v_pk_mul_f32 v[76:77], v[76:77], v[92:93]
v_pk_mul_f32 v[78:79], v[78:79], v[94:95]
v_pk_add_f32 v[64:65], v[64:65], v[208:209]
v_pk_add_f32 v[66:67], v[66:67], v[210:211]
v_pk_add_f32 v[68:69], v[68:69], v[212:213]
v_pk_add_f32 v[70:71], v[70:71], v[214:215]
v_pk_add_f32 v[72:73], v[72:73], v[216:217]
v_pk_add_f32 v[74:75], v[74:75], v[218:219]
v_pk_add_f32 v[76:77], v[76:77], v[220:221]
v_pk_add_f32 v[78:79], v[78:79], v[222:223]
v_cvt_pk_bf16_f32 v96, v64, v65
v_cvt_pk_bf16_f32 v97, v66, v67
v_cvt_pk_bf16_f32 v98, v68, v69
v_cvt_pk_bf16_f32 v99, v70, v71
v_cvt_pk_bf16_f32 v100, v72, v73
v_cvt_pk_bf16_f32 v101, v74, v75
v_cvt_pk_bf16_f32 v102, v76, v77
v_cvt_pk_bf16_f32 v103, v78, v79
s_nop 1
v_permlane32_swap_b32 v96, v98
v_permlane32_swap_b32 v97, v99
v_permlane32_swap_b32 v100, v102
v_permlane32_swap_b32 v101, v103
buffer_store_dwordx4 v[96:99], v21, s[28:31], s57 offen
buffer_store_dwordx4 v[100:103], v21, s[28:31], s57 offen offset:32
Lend:
s_endpgm
.section .rodata,"a"
.p2align 6
.amdhsa_kernel recurrent_scan__spectral_fnet__glu_gated_swiglu__prompt_kernel
  .amdhsa_next_free_vgpr 256
  .amdhsa_next_free_sgpr 102
  .amdhsa_accum_offset 256
  .amdhsa_group_segment_fixed_size 0
  .amdhsa_kernarg_size 96
  .amdhsa_user_sgpr_count 2
  .amdhsa_user_sgpr_kernarg_segment_ptr 1
  .amdhsa_system_sgpr_workgroup_id_x 1
.end_amdhsa_kernel
```
